```python
import torch

def _softmax(x, axis=-1):
    return torch.softmax(x, dim=axis)
def _gelu(x):
    return torch.nn.functional.gelu(x, approximate="tanh")
def _silu(x):
    return torch.nn.functional.silu(x)
def _sigmoid(x):
    return torch.sigmoid(x)
def _layernorm(x, axis=-1, eps=1e-5):
    m = x.mean(dim=axis, keepdim=True)
    v = x.var(dim=axis, keepdim=True, unbiased=False)
    return (x - m) / torch.sqrt(v + eps)
def _scatter_add(tgt, idx, src, axis=0):
    return tgt.clone().index_add_(axis, idx, src)
def _segment_sum(src, seg, n):
    out = torch.zeros((n,) + src.shape[1:], dtype=src.dtype)
    return out.index_add_(0, seg, src)
def _pad(x, pw):
    flat = tuple(v for pair in reversed(pw) for v in pair)
    return torch.nn.functional.pad(x, flat)

kernel_name = 'sequential_preLN__mha_block__mixer_token_mlp__prompt'

def setup_inputs():

    _w = (lambda a: (lambda t: t.to(torch.bfloat16) if t.is_floating_point() else t)(torch.as_tensor(a)))
    def _A_setup():
        B, S, D, H = 1, 2048, 512, 32
        return {
            "x": _w((lambda *s: torch.randn(*s, dtype=torch.bfloat16) * 0.05)(B, S, D)),
            "wqkv": _w((lambda *s: torch.randn(*s, dtype=torch.bfloat16) * 0.05)(D, 3 * D)),
            "wo": _w((lambda *s: torch.randn(*s, dtype=torch.bfloat16) * 0.05)(D, D)),
        }
    _A_in = _A_setup()

    def _B_setup():
        B, S, D, F = 1, 2048, 512, 1792
        return {
            "x": _w((lambda *s: torch.randn(*s, dtype=torch.bfloat16) * 0.05)(B, S, D)),
            "w1": _w((lambda *s: torch.randn(*s, dtype=torch.bfloat16) * 0.8)(S, F) * (S ** -0.5)),
            "b1": _w((lambda *s: torch.randn(*s, dtype=torch.bfloat16) * 12.8)(F) * 0.02),
            "w2": _w((lambda *s: torch.randn(*s, dtype=torch.bfloat16) * 0.2)(F, S) * (F ** -0.5)),
            "b2": _w((lambda *s: torch.randn(*s, dtype=torch.bfloat16) * 3.2)(S) * 0.02),
        }
    _B_in = _B_setup()

    return {
        "A_x": _A_in["x"],
        "A_wqkv": _A_in["wqkv"],
        "A_wo": _A_in["wo"],
        "B_x": _B_in["x"],
        "B_w1": _B_in["w1"],
        "B_b1": _B_in["b1"],
        "B_w2": _B_in["w2"],
        "B_b2": _B_in["b2"],
    }

def reference(A_x, A_wqkv, A_wo, B_x, B_w1, B_b1, B_w2, B_b2):
    def _A_ref(x, wqkv, wo):
        B, S, D = x.shape
        H = 32
        Dh = D // H
        qkv = (lambda x, *d: x.permute(*d))((x @ wqkv).reshape(B, S, 3, H, Dh), 2, 0, 3, 1, 4)
        q, k, v = qkv[0], qkv[1], qkv[2]
        scores = torch.einsum("bhqd,bhkd->bhqk", q, k) * (Dh ** -0.5)
        p = _softmax(scores, axis=-1)
        o = torch.einsum("bhqk,bhkd->bhqd", p, v)
        return (lambda x, *d: x.permute(*d))(o, 0, 2, 1, 3).reshape(B, S, D) @ wo

    def _B_ref(x, w1, b1, w2, b2):
        B, S, D = x.shape
        h = _layernorm(x, axis=-1)
        u = torch.einsum("bsd,sf->bdf", h, w1) + b1
        u = _gelu(u)
        y = torch.einsum("bdf,fs->bds", u, w2) + b2
        return (lambda x, *d: x.permute(*d))(y, 0, 2, 1)

    x = A_x
    h = x + _A_ref(_layernorm(x, axis=-1), A_wqkv, A_wo)
    h2 = h + _B_ref(_layernorm(h, axis=-1), B_w1, B_b1, B_w2, B_b2)
    return h2
```

```asm
; @launch grid=(256,1,1) block=(512,1,1) lds=163840
.amdgcn_target "amdgcn-amd-amdhsa--gfx950"
.text
.globl sequential_preLN__mha_block__mixer_token_mlp__prompt_kernel
.p2align 8
.type sequential_preLN__mha_block__mixer_token_mlp__prompt_kernel,@function
sequential_preLN__mha_block__mixer_token_mlp__prompt_kernel:
    s_cmp_ge_u32 s2, 256
    s_cbranch_scc1 L_end
    s_load_dwordx16 s[4:19], s[0:1], 0
    s_load_dwordx4 s[20:23], s[0:1], 64
    s_load_dwordx2 s[24:25], s[0:1], 80
    v_lshrrev_b32 v1, 6, v0
    v_and_b32 v0, 63, v0
    v_readfirstlane_b32 s3, v1
    s_waitcnt lgkmcnt(0)
    s_mov_b32 s68, s24
    s_mov_b32 s69, s25
    s_mov_b32 s70, 0x1000000
    s_mov_b32 s71, 0x20000
    s_mov_b32 s76, s22
    s_mov_b32 s77, s23
    s_mov_b32 s78, 0x100
    s_mov_b32 s79, 0x20000
    v_mov_b32 v248, 252
    v_mov_b32 v247, 0
    s_getpc_b64 s[62:63]
L_pcbase:
    s_lshl_b32 s60, s3, 13
    v_lshlrev_b32 v6, 7, v0
    v_add_u32 v6, s60, v6
    s_mov_b32 s61, L_codeend-L_pcbase
    v_min_u32 v6, s61, v6
    global_load_dword v249, v6, s[62:63]
    s_cmp_lg_u32 s2, 0
    s_cbranch_scc1 L_zero_1
    s_cmp_lg_u32 s3, 7
    s_cbranch_scc1 L_zero_1
    v_lshlrev_b32 v6, 8, v0
    v_mov_b32 v7, 0
    v_cmp_gt_u32 vcc, 16, v0
    s_and_saveexec_b64 s[62:63], vcc
    s_mov_b32 s60, 14942208
    buffer_store_dword v7, v6, s[68:71], s60 offen sc1
    s_mov_b64 exec, s[62:63]
L_zero_1:
    s_and_b32 s46, s2, 7
    s_lshr_b32 s47, s2, 3
    s_lshl_b32 s48, s46, 2
    s_lshr_b32 s49, s47, 3
    s_add_u32 s48, s48, s49
    s_and_b32 s49, s47, 7
    s_lshl_b32 s50, s49, 3
    s_add_u32 s50, s50, s3
    s_lshl_b32 s50, s50, 5
    s_add_u32 s50, s50, s48
    s_lshl_b32 s50, s50, 10
    s_add_u32 s96, s50, 6291456
    s_lshl_b32 s50, s49, 1
    s_and_b32 s51, s3, 1
    s_add_u32 s50, s50, s51
    s_lshl_b32 s50, s50, 7
    s_lshl_b32 s51, s48, 2
    s_add_u32 s50, s50, s51
    s_lshr_b32 s51, s3, 1
    s_add_u32 s50, s50, s51
    s_lshl_b32 s50, s50, 10
    s_add_u32 s97, s50, 10485760
    s_and_b32 s50, s46, 1
    s_lshl_b32 s50, s50, 2
    s_and_b32 s51, s47, 3
    s_add_u32 s50, s50, s51
    s_lshr_b32 s51, s46, 1
    s_mul_i32 s51, s51, 7
    s_lshr_b32 s52, s47, 2
    s_min_u32 s52, s52, 6
    s_add_u32 s51, s51, s52
    s_lshl_b32 s99, s51, 7
    s_cmp_lt_u32 s47, 28
    s_cselect_b32 s100, 1, 0
    s_lshl_b32 s50, s50, 1
    s_lshr_b32 s52, s3, 2
    s_add_u32 s50, s50, s52
    s_mul_i32 s50, s50, 112
    s_lshl_b32 s51, s51, 2
    s_add_u32 s50, s50, s51
    s_and_b32 s51, s3, 1
    s_lshl_b32 s51, s51, 1
    s_add_u32 s50, s50, s51
    s_bfe_u32 s51, s3, 0x10001
    s_add_u32 s50, s50, s51
    s_lshl_b32 s50, s50, 10
    s_add_u32 s98, s50, 12582912
    s_and_b32 s46, s2, 7
    s_lshr_b32 s47, s2, 3
    s_lshr_b32 s48, s46, 1
    s_lshl_b32 s48, s48, 3
    s_and_b32 s49, s47, 7
    s_add_u32 s26, s48, s49
    s_mov_b32 s28, s4
    s_mov_b32 s29, s5
    s_mov_b32 s30, 0x200000
    s_mov_b32 s31, 0x20000
    v_lshrrev_b32 v1, 3, v0
    s_lshl_b32 s50, s3, 3
    v_add_u32 v2, s50, v1
    s_lshl_b32 s51, s26, 6
    v_add_u32 v3, s51, v2
    v_lshlrev_b32 v3, 10, v3
    v_and_b32 v4, 7, v0
    v_lshlrev_b32 v5, 4, v4
    v_add_u32 v3, v3, v5
    buffer_load_dwordx4 v[8:11], v3, s[28:31], 0 offen offset:0
    buffer_load_dwordx4 v[12:15], v3, s[28:31], 0 offen offset:128
    buffer_load_dwordx4 v[16:19], v3, s[28:31], 0 offen offset:256
    buffer_load_dwordx4 v[20:23], v3, s[28:31], 0 offen offset:384
    buffer_load_dwordx4 v[24:27], v3, s[28:31], 0 offen offset:512
    buffer_load_dwordx4 v[28:31], v3, s[28:31], 0 offen offset:640
    buffer_load_dwordx4 v[32:35], v3, s[28:31], 0 offen offset:768
    buffer_load_dwordx4 v[36:39], v3, s[28:31], 0 offen offset:896
    s_and_b32 s48, s46, 1
    s_lshl_b32 s48, s48, 2
    s_lshr_b32 s49, s47, 3
    s_add_u32 s27, s48, s49
    s_and_b32 s44, s3, 1
    s_bfe_u32 s45, s3, 0x10001
    s_mov_b32 s32, s6
    s_mov_b32 s33, s7
    s_mov_b32 s34, 0x180000
    s_mov_b32 s35, 0x20000
    s_mov_b32 s36, s24
    s_mov_b32 s37, s25
    s_mov_b32 s38, 0x1000000
    s_mov_b32 s39, 0x20000
    s_barrier
    v_lshrrev_b32 v5, 3, v0
    s_mov_b32 s65, 3072
    v_mul_lo_u32 v47, v5, s65
    v_bfe_u32 v5, v0, 4, 1
    v_lshlrev_b32 v5, 2, v5
    v_and_b32 v6, 7, v0
    v_xor_b32 v5, v5, v6
    v_lshlrev_b32 v5, 4, v5
    v_add_u32 v47, v47, v5
    s_mul_i32 s46, s3, 24576
    s_lshl_b32 s47, s27, 7
    s_add_u32 s46, s46, s47
    v_add_u32 v47, s46, v47
    s_lshl_b32 s50, s3, 10
    s_add_u32 s50, s50, 65536
    s_mov_b32 m0, s50
    s_mov_b32 s51, 0
    buffer_load_dwordx4 v47, s[32:35], s51 offen lds
    s_add_u32 m0, s50, 8192
    s_mov_b32 s51, 1024
    buffer_load_dwordx4 v47, s[32:35], s51 offen lds
    s_add_u32 m0, s50, 16384
    s_mov_b32 s51, 2048
    buffer_load_dwordx4 v47, s[32:35], s51 offen lds
    s_add_u32 m0, s50, 24576
    s_mov_b32 s51, 196608
    buffer_load_dwordx4 v47, s[32:35], s51 offen lds
    s_add_u32 m0, s50, 32768
    s_mov_b32 s51, 197632
    buffer_load_dwordx4 v47, s[32:35], s51 offen lds
    s_add_u32 m0, s50, 40960
    s_mov_b32 s51, 198656
    buffer_load_dwordx4 v47, s[32:35], s51 offen lds
    v_and_b32 v5, 15, v2
    v_xor_b32 v5, v5, v4
    v_lshlrev_b32 v5, 4, v5
    v_lshlrev_b32 v46, 10, v2
    v_add_u32 v46, v46, v5
    v_xor_b32 v43, 128, v46
    v_and_b32 v1, 31, v0
    s_lshl_b32 s46, s44, 5
    v_add_u32 v1, s46, v1
    v_and_b32 v2, 15, v1
    v_lshlrev_b32 v1, 10, v1
    v_lshrrev_b32 v3, 5, v0
    v_add_u32 v4, 0, v3
    v_xor_b32 v4, v4, v2
    v_lshlrev_b32 v4, 4, v4
    v_add_u32 v48, v1, v4
    v_add_u32 v4, 2, v3
    v_xor_b32 v4, v4, v2
    v_lshlrev_b32 v4, 4, v4
    v_add_u32 v49, v1, v4
    v_add_u32 v4, 4, v3
    v_xor_b32 v4, v4, v2
    v_lshlrev_b32 v4, 4, v4
    v_add_u32 v50, v1, v4
    v_add_u32 v4, 6, v3
    v_xor_b32 v4, v4, v2
    v_lshlrev_b32 v4, 4, v4
    v_add_u32 v51, v1, v4
    v_add_u32 v4, 8, v3
    v_xor_b32 v4, v4, v2
    v_lshlrev_b32 v4, 4, v4
    v_add_u32 v52, v1, v4
    v_add_u32 v4, 10, v3
    v_xor_b32 v4, v4, v2
    v_lshlrev_b32 v4, 4, v4
    v_add_u32 v53, v1, v4
    v_add_u32 v4, 12, v3
    v_xor_b32 v4, v4, v2
    v_lshlrev_b32 v4, 4, v4
    v_add_u32 v54, v1, v4
    v_add_u32 v4, 14, v3
    v_xor_b32 v4, v4, v2
    v_lshlrev_b32 v4, 4, v4
    v_add_u32 v55, v1, v4
    s_lshl_b32 s46, s45, 2
    v_lshrrev_b32 v1, 5, v0
    v_lshlrev_b32 v1, 3, v1
    v_bfe_u32 v2, v0, 2, 2
    v_add_u32 v1, v1, v2
    v_lshlrev_b32 v56, 7, v1
    v_bfe_u32 v1, v0, 4, 1
    v_lshlrev_b32 v1, 1, v1
    v_bfe_u32 v2, v0, 1, 1
    v_add_u32 v1, v1, v2
    v_add_u32 v1, s46, v1
    v_bfe_u32 v2, v0, 3, 1
    v_lshlrev_b32 v2, 2, v2
    v_xor_b32 v1, v1, v2
    v_lshlrev_b32 v1, 4, v1
    v_add_u32 v56, v56, v1
    v_and_b32 v1, 1, v0
    v_lshlrev_b32 v1, 3, v1
    v_add_u32 v56, v56, v1
    v_add_u32 v56, 0x10000, v56
    v_add_u32 v57, 49152, v56
    s_waitcnt vmcnt(6)
    s_cmp_lg_u32 s2, 0
    s_cbranch_scc1 L_zs_2
    s_cmp_lg_u32 s3, 7
    s_cbranch_scc1 L_zs_2
    v_mov_b32 v126, 1
    v_cmp_eq_u32 vcc, 0, v0
    s_and_saveexec_b64 s[62:63], vcc
    buffer_store_dword v126, v248, s[76:79], 0 offen sc1
    s_mov_b64 exec, s[62:63]
L_zs_2:
    v_mov_b32 v40, 0
    v_mov_b32 v41, 0
    v_mov_b32 v42, 0x3f803f80
    v_dot2c_f32_bf16 v40, v8, v42
    v_dot2c_f32_bf16 v41, v8, v8
    v_dot2c_f32_bf16 v40, v9, v42
    v_dot2c_f32_bf16 v41, v9, v9
    v_dot2c_f32_bf16 v40, v10, v42
    v_dot2c_f32_bf16 v41, v10, v10
    v_dot2c_f32_bf16 v40, v11, v42
    v_dot2c_f32_bf16 v41, v11, v11
    v_dot2c_f32_bf16 v40, v12, v42
    v_dot2c_f32_bf16 v41, v12, v12
    v_dot2c_f32_bf16 v40, v13, v42
    v_dot2c_f32_bf16 v41, v13, v13
    v_dot2c_f32_bf16 v40, v14, v42
    v_dot2c_f32_bf16 v41, v14, v14
    v_dot2c_f32_bf16 v40, v15, v42
    v_dot2c_f32_bf16 v41, v15, v15
    v_dot2c_f32_bf16 v40, v16, v42
    v_dot2c_f32_bf16 v41, v16, v16
    v_dot2c_f32_bf16 v40, v17, v42
    v_dot2c_f32_bf16 v41, v17, v17
    v_dot2c_f32_bf16 v40, v18, v42
    v_dot2c_f32_bf16 v41, v18, v18
    v_dot2c_f32_bf16 v40, v19, v42
    v_dot2c_f32_bf16 v41, v19, v19
    v_dot2c_f32_bf16 v40, v20, v42
    v_dot2c_f32_bf16 v41, v20, v20
    v_dot2c_f32_bf16 v40, v21, v42
    v_dot2c_f32_bf16 v41, v21, v21
    v_dot2c_f32_bf16 v40, v22, v42
    v_dot2c_f32_bf16 v41, v22, v22
    v_dot2c_f32_bf16 v40, v23, v42
    v_dot2c_f32_bf16 v41, v23, v23
    v_dot2c_f32_bf16 v40, v24, v42
    v_dot2c_f32_bf16 v41, v24, v24
    v_dot2c_f32_bf16 v40, v25, v42
    v_dot2c_f32_bf16 v41, v25, v25
    v_dot2c_f32_bf16 v40, v26, v42
    v_dot2c_f32_bf16 v41, v26, v26
    v_dot2c_f32_bf16 v40, v27, v42
    v_dot2c_f32_bf16 v41, v27, v27
    v_dot2c_f32_bf16 v40, v28, v42
    v_dot2c_f32_bf16 v41, v28, v28
    v_dot2c_f32_bf16 v40, v29, v42
    v_dot2c_f32_bf16 v41, v29, v29
    v_dot2c_f32_bf16 v40, v30, v42
    v_dot2c_f32_bf16 v41, v30, v30
    v_dot2c_f32_bf16 v40, v31, v42
    v_dot2c_f32_bf16 v41, v31, v31
    v_dot2c_f32_bf16 v40, v32, v42
    v_dot2c_f32_bf16 v41, v32, v32
    v_dot2c_f32_bf16 v40, v33, v42
    v_dot2c_f32_bf16 v41, v33, v33
    v_dot2c_f32_bf16 v40, v34, v42
    v_dot2c_f32_bf16 v41, v34, v34
    v_dot2c_f32_bf16 v40, v35, v42
    v_dot2c_f32_bf16 v41, v35, v35
    v_dot2c_f32_bf16 v40, v36, v42
    v_dot2c_f32_bf16 v41, v36, v36
    v_dot2c_f32_bf16 v40, v37, v42
    v_dot2c_f32_bf16 v41, v37, v37
    v_dot2c_f32_bf16 v40, v38, v42
    v_dot2c_f32_bf16 v41, v38, v38
    v_dot2c_f32_bf16 v40, v39, v42
    v_dot2c_f32_bf16 v41, v39, v39
    s_nop 2
    v_add_f32_dpp v40, v40, v40 quad_perm:[1,0,3,2] row_mask:0xf bank_mask:0xf
    v_add_f32_dpp v41, v41, v41 quad_perm:[1,0,3,2] row_mask:0xf bank_mask:0xf
    s_nop 0
    v_add_f32_dpp v40, v40, v40 quad_perm:[2,3,0,1] row_mask:0xf bank_mask:0xf
    v_add_f32_dpp v41, v41, v41 quad_perm:[2,3,0,1] row_mask:0xf bank_mask:0xf
    s_nop 0
    v_add_f32_dpp v40, v40, v40 row_half_mirror row_mask:0xf bank_mask:0xf
    v_add_f32_dpp v41, v41, v41 row_half_mirror row_mask:0xf bank_mask:0xf
    s_nop 0
    v_mul_f32 v40, 0x3b000000, v40
    v_mul_f32 v41, 0x3b000000, v41
    v_fma_f32 v41, -v40, v40, v41
    v_max_f32 v41, 0, v41
    v_add_f32 v41, 0x3727c5ac, v41
    v_rsq_f32 v60, v41
    s_nop 0
    v_mul_f32 v62, v40, v60
    v_sub_f32 v62, 0, v62
    v_lshlrev_b32 v44, 16, v8
    v_and_b32 v45, 0xffff0000, v8
    v_pk_fma_f32 v[44:45], v[44:45], v[60:61], v[62:63] op_sel_hi:[1,0,0]
    v_cvt_pk_bf16_f32 v8, v44, v45
    v_lshlrev_b32 v120, 16, v9
    v_and_b32 v121, 0xffff0000, v9
    v_pk_fma_f32 v[120:121], v[120:121], v[60:61], v[62:63] op_sel_hi:[1,0,0]
    v_cvt_pk_bf16_f32 v9, v120, v121
    v_lshlrev_b32 v44, 16, v10
    v_and_b32 v45, 0xffff0000, v10
    v_pk_fma_f32 v[44:45], v[44:45], v[60:61], v[62:63] op_sel_hi:[1,0,0]
    v_cvt_pk_bf16_f32 v10, v44, v45
    v_lshlrev_b32 v120, 16, v11
    v_and_b32 v121, 0xffff0000, v11
    v_pk_fma_f32 v[120:121], v[120:121], v[60:61], v[62:63] op_sel_hi:[1,0,0]
    v_cvt_pk_bf16_f32 v11, v120, v121
    ds_write_b128 v46, v[8:11] offset:0
    s_add_u32 m0, s50, 49152
    s_mov_b32 s51, 393216
    buffer_load_dwordx4 v47, s[32:35], s51 offen lds
    s_add_u32 m0, s50, 57344
    s_mov_b32 s51, 394240
    buffer_load_dwordx4 v47, s[32:35], s51 offen lds
    s_add_u32 m0, s50, 65536
    s_mov_b32 s51, 395264
    buffer_load_dwordx4 v47, s[32:35], s51 offen lds
    v_lshlrev_b32 v44, 16, v12
    v_and_b32 v45, 0xffff0000, v12
    v_pk_fma_f32 v[44:45], v[44:45], v[60:61], v[62:63] op_sel_hi:[1,0,0]
    v_cvt_pk_bf16_f32 v12, v44, v45
    v_lshlrev_b32 v120, 16, v13
    v_and_b32 v121, 0xffff0000, v13
    v_pk_fma_f32 v[120:121], v[120:121], v[60:61], v[62:63] op_sel_hi:[1,0,0]
    v_cvt_pk_bf16_f32 v13, v120, v121
    v_lshlrev_b32 v44, 16, v14
    v_and_b32 v45, 0xffff0000, v14
    v_pk_fma_f32 v[44:45], v[44:45], v[60:61], v[62:63] op_sel_hi:[1,0,0]
    v_cvt_pk_bf16_f32 v14, v44, v45
    v_lshlrev_b32 v120, 16, v15
    v_and_b32 v121, 0xffff0000, v15
    v_pk_fma_f32 v[120:121], v[120:121], v[60:61], v[62:63] op_sel_hi:[1,0,0]
    v_cvt_pk_bf16_f32 v15, v120, v121
    ds_write_b128 v43, v[12:15] offset:0
    v_lshlrev_b32 v44, 16, v16
    v_and_b32 v45, 0xffff0000, v16
    v_pk_fma_f32 v[44:45], v[44:45], v[60:61], v[62:63] op_sel_hi:[1,0,0]
    v_cvt_pk_bf16_f32 v16, v44, v45
    v_lshlrev_b32 v120, 16, v17
    v_and_b32 v121, 0xffff0000, v17
    v_pk_fma_f32 v[120:121], v[120:121], v[60:61], v[62:63] op_sel_hi:[1,0,0]
    v_cvt_pk_bf16_f32 v17, v120, v121
    v_lshlrev_b32 v44, 16, v18
    v_and_b32 v45, 0xffff0000, v18
    v_pk_fma_f32 v[44:45], v[44:45], v[60:61], v[62:63] op_sel_hi:[1,0,0]
    v_cvt_pk_bf16_f32 v18, v44, v45
    v_lshlrev_b32 v120, 16, v19
    v_and_b32 v121, 0xffff0000, v19
    v_pk_fma_f32 v[120:121], v[120:121], v[60:61], v[62:63] op_sel_hi:[1,0,0]
    v_cvt_pk_bf16_f32 v19, v120, v121
    ds_write_b128 v46, v[16:19] offset:256
    s_add_u32 m0, s50, 73728
    s_mov_b32 s51, 589824
    buffer_load_dwordx4 v47, s[32:35], s51 offen lds
    s_add_u32 m0, s50, 81920
    s_mov_b32 s51, 590848
    buffer_load_dwordx4 v47, s[32:35], s51 offen lds
    s_add_u32 m0, s50, 90112
    s_mov_b32 s51, 591872
    buffer_load_dwordx4 v47, s[32:35], s51 offen lds
    v_lshlrev_b32 v44, 16, v20
    v_and_b32 v45, 0xffff0000, v20
    v_pk_fma_f32 v[44:45], v[44:45], v[60:61], v[62:63] op_sel_hi:[1,0,0]
    v_cvt_pk_bf16_f32 v20, v44, v45
    v_lshlrev_b32 v120, 16, v21
    v_and_b32 v121, 0xffff0000, v21
    v_pk_fma_f32 v[120:121], v[120:121], v[60:61], v[62:63] op_sel_hi:[1,0,0]
    v_cvt_pk_bf16_f32 v21, v120, v121
    v_lshlrev_b32 v44, 16, v22
    v_and_b32 v45, 0xffff0000, v22
    v_pk_fma_f32 v[44:45], v[44:45], v[60:61], v[62:63] op_sel_hi:[1,0,0]
    v_cvt_pk_bf16_f32 v22, v44, v45
    v_lshlrev_b32 v120, 16, v23
    v_and_b32 v121, 0xffff0000, v23
    v_pk_fma_f32 v[120:121], v[120:121], v[60:61], v[62:63] op_sel_hi:[1,0,0]
    v_cvt_pk_bf16_f32 v23, v120, v121
    ds_write_b128 v43, v[20:23] offset:256
    v_lshlrev_b32 v44, 16, v24
    v_and_b32 v45, 0xffff0000, v24
    v_pk_fma_f32 v[44:45], v[44:45], v[60:61], v[62:63] op_sel_hi:[1,0,0]
    v_cvt_pk_bf16_f32 v24, v44, v45
    v_lshlrev_b32 v120, 16, v25
    v_and_b32 v121, 0xffff0000, v25
    v_pk_fma_f32 v[120:121], v[120:121], v[60:61], v[62:63] op_sel_hi:[1,0,0]
    v_cvt_pk_bf16_f32 v25, v120, v121
    v_lshlrev_b32 v44, 16, v26
    v_and_b32 v45, 0xffff0000, v26
    v_pk_fma_f32 v[44:45], v[44:45], v[60:61], v[62:63] op_sel_hi:[1,0,0]
    v_cvt_pk_bf16_f32 v26, v44, v45
    v_lshlrev_b32 v120, 16, v27
    v_and_b32 v121, 0xffff0000, v27
    v_pk_fma_f32 v[120:121], v[120:121], v[60:61], v[62:63] op_sel_hi:[1,0,0]
    v_cvt_pk_bf16_f32 v27, v120, v121
    ds_write_b128 v46, v[24:27] offset:512
    v_lshlrev_b32 v44, 16, v28
    v_and_b32 v45, 0xffff0000, v28
    v_pk_fma_f32 v[44:45], v[44:45], v[60:61], v[62:63] op_sel_hi:[1,0,0]
    v_cvt_pk_bf16_f32 v28, v44, v45
    v_lshlrev_b32 v120, 16, v29
    v_and_b32 v121, 0xffff0000, v29
    v_pk_fma_f32 v[120:121], v[120:121], v[60:61], v[62:63] op_sel_hi:[1,0,0]
    v_cvt_pk_bf16_f32 v29, v120, v121
    v_lshlrev_b32 v44, 16, v30
    v_and_b32 v45, 0xffff0000, v30
    v_pk_fma_f32 v[44:45], v[44:45], v[60:61], v[62:63] op_sel_hi:[1,0,0]
    v_cvt_pk_bf16_f32 v30, v44, v45
    v_lshlrev_b32 v120, 16, v31
    v_and_b32 v121, 0xffff0000, v31
    v_pk_fma_f32 v[120:121], v[120:121], v[60:61], v[62:63] op_sel_hi:[1,0,0]
    v_cvt_pk_bf16_f32 v31, v120, v121
    ds_write_b128 v43, v[28:31] offset:512
    s_lshr_b32 s46, s2, 3
    s_and_b32 s46, s46, 7
    s_lshl_b32 s46, s46, 5
    s_and_b32 s47, s3, 1
    s_lshl_b32 s47, s47, 4
    s_add_u32 s46, s46, s47
    s_add_u32 s46, s46, 256
    v_and_b32 v6, 15, v0
    v_add_u32 v6, s46, v6
    s_movk_i32 s47, 3072
    v_mul_lo_u32 v6, v6, s47
    s_lshr_b32 s46, s3, 1
    s_min_u32 s46, s46, 2
    s_lshl_b32 s46, s46, 10
    s_lshl_b32 s47, s27, 7
    s_add_u32 s46, s46, s47
    v_cmp_gt_u32 vcc, 16, v0
    s_and_saveexec_b64 s[52:53], vcc
    buffer_load_dword v125, v6, s[32:35], s46 offen
    s_mov_b64 exec, s[52:53]
    v_lshlrev_b32 v44, 16, v32
    v_and_b32 v45, 0xffff0000, v32
    v_pk_fma_f32 v[44:45], v[44:45], v[60:61], v[62:63] op_sel_hi:[1,0,0]
    v_cvt_pk_bf16_f32 v32, v44, v45
    v_lshlrev_b32 v120, 16, v33
    v_and_b32 v121, 0xffff0000, v33
    v_pk_fma_f32 v[120:121], v[120:121], v[60:61], v[62:63] op_sel_hi:[1,0,0]
    v_cvt_pk_bf16_f32 v33, v120, v121
    v_lshlrev_b32 v44, 16, v34
    v_and_b32 v45, 0xffff0000, v34
    v_pk_fma_f32 v[44:45], v[44:45], v[60:61], v[62:63] op_sel_hi:[1,0,0]
    v_cvt_pk_bf16_f32 v34, v44, v45
    v_lshlrev_b32 v120, 16, v35
    v_and_b32 v121, 0xffff0000, v35
    v_pk_fma_f32 v[120:121], v[120:121], v[60:61], v[62:63] op_sel_hi:[1,0,0]
    v_cvt_pk_bf16_f32 v35, v120, v121
    ds_write_b128 v46, v[32:35] offset:768
    v_lshlrev_b32 v44, 16, v36
    v_and_b32 v45, 0xffff0000, v36
    v_pk_fma_f32 v[44:45], v[44:45], v[60:61], v[62:63] op_sel_hi:[1,0,0]
    v_cvt_pk_bf16_f32 v36, v44, v45
    v_lshlrev_b32 v120, 16, v37
    v_and_b32 v121, 0xffff0000, v37
    v_pk_fma_f32 v[120:121], v[120:121], v[60:61], v[62:63] op_sel_hi:[1,0,0]
    v_cvt_pk_bf16_f32 v37, v120, v121
    v_lshlrev_b32 v44, 16, v38
    v_and_b32 v45, 0xffff0000, v38
    v_pk_fma_f32 v[44:45], v[44:45], v[60:61], v[62:63] op_sel_hi:[1,0,0]
    v_cvt_pk_bf16_f32 v38, v44, v45
    v_lshlrev_b32 v120, 16, v39
    v_and_b32 v121, 0xffff0000, v39
    v_pk_fma_f32 v[120:121], v[120:121], v[60:61], v[62:63] op_sel_hi:[1,0,0]
    v_cvt_pk_bf16_f32 v39, v120, v121
    ds_write_b128 v43, v[36:39] offset:768
    s_cmp_ge_u32 s3, 4
    s_cbranch_scc1 L_p1_v_3
    v_mov_b32 v64, 0
    v_mov_b32 v65, 0
    v_mov_b32 v66, 0
    v_mov_b32 v67, 0
    v_mov_b32 v68, 0
    v_mov_b32 v69, 0
    v_mov_b32 v70, 0
    v_mov_b32 v71, 0
    v_mov_b32 v72, 0
    v_mov_b32 v73, 0
    v_mov_b32 v74, 0
    v_mov_b32 v75, 0
    v_mov_b32 v76, 0
    v_mov_b32 v77, 0
    v_mov_b32 v78, 0
    v_mov_b32 v79, 0
    v_mov_b32 v80, 0
    v_mov_b32 v81, 0
    v_mov_b32 v82, 0
    v_mov_b32 v83, 0
    v_mov_b32 v84, 0
    v_mov_b32 v85, 0
    v_mov_b32 v86, 0
    v_mov_b32 v87, 0
    v_mov_b32 v88, 0
    v_mov_b32 v89, 0
    v_mov_b32 v90, 0
    v_mov_b32 v91, 0
    v_mov_b32 v92, 0
    v_mov_b32 v93, 0
    v_mov_b32 v94, 0
    v_mov_b32 v95, 0
    s_waitcnt vmcnt(10) lgkmcnt(0)
    s_barrier
    ds_read_b128 v[128:131], v48 offset:0
    ds_read_b64_tr_b16 v[140:141], v56 offset:0
    ds_read_b64_tr_b16 v[142:143], v56 offset:512
    ds_read_b64_tr_b16 v[152:153], v56 offset:8192
    ds_read_b64_tr_b16 v[154:155], v56 offset:8704
    ds_read_b128 v[132:135], v49 offset:0
    ds_read_b64_tr_b16 v[144:145], v56 offset:2048
    ds_read_b64_tr_b16 v[146:147], v56 offset:2560
    ds_read_b64_tr_b16 v[156:157], v56 offset:10240
    ds_read_b64_tr_b16 v[158:159], v56 offset:10752
    ds_read_b128 v[136:139], v50 offset:0
    ds_read_b64_tr_b16 v[148:149], v56 offset:4096
    ds_read_b64_tr_b16 v[150:151], v56 offset:4608
    ds_read_b64_tr_b16 v[160:161], v56 offset:12288
    ds_read_b64_tr_b16 v[162:163], v56 offset:12800
    s_waitcnt lgkmcnt(10)
    v_mfma_f32_32x32x16_bf16 v[64:79], v[140:143], v[128:131], v[64:79]
    v_mfma_f32_32x32x16_bf16 v[80:95], v[152:155], v[128:131], v[80:95]
    ds_read_b128 v[128:131], v51 offset:0
    ds_read_b64_tr_b16 v[140:141], v56 offset:6144
    ds_read_b64_tr_b16 v[142:143], v56 offset:6656
    ds_read_b64_tr_b16 v[152:153], v56 offset:14336
    ds_read_b64_tr_b16 v[154:155], v56 offset:14848
    s_waitcnt lgkmcnt(10)
    v_mfma_f32_32x32x16_bf16 v[64:79], v[144:147], v[132:135], v[64:79]
    v_mfma_f32_32x32x16_bf16 v[80:95], v[156:159], v[132:135], v[80:95]
    s_waitcnt vmcnt(7)
    s_barrier
    ds_read_b128 v[132:135], v52 offset:0
    ds_read_b64_tr_b16 v[144:145], v56 offset:24576
    ds_read_b64_tr_b16 v[146:147], v56 offset:25088
    ds_read_b64_tr_b16 v[156:157], v56 offset:32768
    ds_read_b64_tr_b16 v[158:159], v56 offset:33280
    s_waitcnt lgkmcnt(10)
    v_mfma_f32_32x32x16_bf16 v[64:79], v[148:151], v[136:139], v[64:79]
    v_mfma_f32_32x32x16_bf16 v[80:95], v[160:163], v[136:139], v[80:95]
    ds_read_b128 v[136:139], v53 offset:0
    ds_read_b64_tr_b16 v[148:149], v56 offset:26624
    ds_read_b64_tr_b16 v[150:151], v56 offset:27136
    ds_read_b64_tr_b16 v[160:161], v56 offset:34816
    ds_read_b64_tr_b16 v[162:163], v56 offset:35328
    s_waitcnt lgkmcnt(10)
    v_mfma_f32_32x32x16_bf16 v[64:79], v[140:143], v[128:131], v[64:79]
    v_mfma_f32_32x32x16_bf16 v[80:95], v[152:155], v[128:131], v[80:95]
    ds_read_b128 v[128:131], v54 offset:0
    ds_read_b64_tr_b16 v[140:141], v56 offset:28672
    ds_read_b64_tr_b16 v[142:143], v56 offset:29184
    ds_read_b64_tr_b16 v[152:153], v56 offset:36864
    ds_read_b64_tr_b16 v[154:155], v56 offset:37376
    s_waitcnt lgkmcnt(10)
    v_mfma_f32_32x32x16_bf16 v[64:79], v[144:147], v[132:135], v[64:79]
    v_mfma_f32_32x32x16_bf16 v[80:95], v[156:159], v[132:135], v[80:95]
    ds_read_b128 v[132:135], v55 offset:0
    ds_read_b64_tr_b16 v[144:145], v56 offset:30720
    ds_read_b64_tr_b16 v[146:147], v56 offset:31232
    ds_read_b64_tr_b16 v[156:157], v56 offset:38912
    ds_read_b64_tr_b16 v[158:159], v56 offset:39424
    s_waitcnt lgkmcnt(10)
    v_mfma_f32_32x32x16_bf16 v[64:79], v[148:151], v[136:139], v[64:79]
    v_mfma_f32_32x32x16_bf16 v[80:95], v[160:163], v[136:139], v[80:95]
    s_waitcnt vmcnt(4)
    s_barrier
    s_mov_b32 m0, s50
    s_mov_b32 s51, 786432
    buffer_load_dwordx4 v47, s[32:35], s51 offen lds
    s_add_u32 m0, s50, 8192
    s_mov_b32 s51, 787456
    buffer_load_dwordx4 v47, s[32:35], s51 offen lds
    s_add_u32 m0, s50, 16384
    s_mov_b32 s51, 788480
    buffer_load_dwordx4 v47, s[32:35], s51 offen lds
    ds_read_b128 v[136:139], v48 offset:256
    ds_read_b64_tr_b16 v[148:149], v57 offset:0
    ds_read_b64_tr_b16 v[150:151], v57 offset:512
    ds_read_b64_tr_b16 v[160:161], v57 offset:8192
    ds_read_b64_tr_b16 v[162:163], v57 offset:8704
    s_waitcnt lgkmcnt(10)
    v_mfma_f32_32x32x16_bf16 v[64:79], v[140:143], v[128:131], v[64:79]
    v_mfma_f32_32x32x16_bf16 v[80:95], v[152:155], v[128:131], v[80:95]
    ds_read_b128 v[128:131], v49 offset:256
    ds_read_b64_tr_b16 v[140:141], v57 offset:2048
    ds_read_b64_tr_b16 v[142:143], v57 offset:2560
    ds_read_b64_tr_b16 v[152:153], v57 offset:10240
    ds_read_b64_tr_b16 v[154:155], v57 offset:10752
    s_waitcnt lgkmcnt(10)
    v_mfma_f32_32x32x16_bf16 v[64:79], v[144:147], v[132:135], v[64:79]
    v_mfma_f32_32x32x16_bf16 v[80:95], v[156:159], v[132:135], v[80:95]
    ds_read_b128 v[132:135], v50 offset:256
    ds_read_b64_tr_b16 v[144:145], v57 offset:4096
    ds_read_b64_tr_b16 v[146:147], v57 offset:4608
    ds_read_b64_tr_b16 v[156:157], v57 offset:12288
    ds_read_b64_tr_b16 v[158:159], v57 offset:12800
    s_waitcnt lgkmcnt(10)
    v_mfma_f32_32x32x16_bf16 v[64:79], v[148:151], v[136:139], v[64:79]
    v_mfma_f32_32x32x16_bf16 v[80:95], v[160:163], v[136:139], v[80:95]
    ds_read_b128 v[136:139], v51 offset:256
    ds_read_b64_tr_b16 v[148:149], v57 offset:6144
    ds_read_b64_tr_b16 v[150:151], v57 offset:6656
    ds_read_b64_tr_b16 v[160:161], v57 offset:14336
    ds_read_b64_tr_b16 v[162:163], v57 offset:14848
    s_waitcnt lgkmcnt(10)
    v_mfma_f32_32x32x16_bf16 v[64:79], v[140:143], v[128:131], v[64:79]
    v_mfma_f32_32x32x16_bf16 v[80:95], v[152:155], v[128:131], v[80:95]
    s_waitcnt vmcnt(4)
    s_barrier
    s_add_u32 m0, s50, 24576
    s_mov_b32 s51, 983040
    buffer_load_dwordx4 v47, s[32:35], s51 offen lds
    s_add_u32 m0, s50, 32768
    s_mov_b32 s51, 984064
    buffer_load_dwordx4 v47, s[32:35], s51 offen lds
    s_add_u32 m0, s50, 40960
    s_mov_b32 s51, 985088
    buffer_load_dwordx4 v47, s[32:35], s51 offen lds
    ds_read_b128 v[128:131], v52 offset:256
    ds_read_b64_tr_b16 v[140:141], v57 offset:24576
    ds_read_b64_tr_b16 v[142:143], v57 offset:25088
    ds_read_b64_tr_b16 v[152:153], v57 offset:32768
    ds_read_b64_tr_b16 v[154:155], v57 offset:33280
    s_waitcnt lgkmcnt(10)
    v_mfma_f32_32x32x16_bf16 v[64:79], v[144:147], v[132:135], v[64:79]
    v_mfma_f32_32x32x16_bf16 v[80:95], v[156:159], v[132:135], v[80:95]
    ds_read_b128 v[132:135], v53 offset:256
    ds_read_b64_tr_b16 v[144:145], v57 offset:26624
    ds_read_b64_tr_b16 v[146:147], v57 offset:27136
    ds_read_b64_tr_b16 v[156:157], v57 offset:34816
    ds_read_b64_tr_b16 v[158:159], v57 offset:35328
    s_waitcnt lgkmcnt(10)
    v_mfma_f32_32x32x16_bf16 v[64:79], v[148:151], v[136:139], v[64:79]
    v_mfma_f32_32x32x16_bf16 v[80:95], v[160:163], v[136:139], v[80:95]
    ds_read_b128 v[136:139], v54 offset:256
    ds_read_b64_tr_b16 v[148:149], v57 offset:28672
    ds_read_b64_tr_b16 v[150:151], v57 offset:29184
    ds_read_b64_tr_b16 v[160:161], v57 offset:36864
    ds_read_b64_tr_b16 v[162:163], v57 offset:37376
    s_waitcnt lgkmcnt(10)
    v_mfma_f32_32x32x16_bf16 v[64:79], v[140:143], v[128:131], v[64:79]
    v_mfma_f32_32x32x16_bf16 v[80:95], v[152:155], v[128:131], v[80:95]
    ds_read_b128 v[128:131], v55 offset:256
    ds_read_b64_tr_b16 v[140:141], v57 offset:30720
    ds_read_b64_tr_b16 v[142:143], v57 offset:31232
    ds_read_b64_tr_b16 v[152:153], v57 offset:38912
    ds_read_b64_tr_b16 v[154:155], v57 offset:39424
    s_waitcnt lgkmcnt(10)
    v_mfma_f32_32x32x16_bf16 v[64:79], v[144:147], v[132:135], v[64:79]
    v_mfma_f32_32x32x16_bf16 v[80:95], v[156:159], v[132:135], v[80:95]
    s_waitcnt vmcnt(3)
    s_barrier
    s_add_u32 m0, s50, 49152
    s_mov_b32 s51, 1179648
    buffer_load_dwordx4 v47, s[32:35], s51 offen lds
    s_add_u32 m0, s50, 57344
    s_mov_b32 s51, 1180672
    buffer_load_dwordx4 v47, s[32:35], s51 offen lds
    s_add_u32 m0, s50, 65536
    s_mov_b32 s51, 1181696
    buffer_load_dwordx4 v47, s[32:35], s51 offen lds
    ds_read_b128 v[132:135], v48 offset:512
    ds_read_b64_tr_b16 v[144:145], v56 offset:0
    ds_read_b64_tr_b16 v[146:147], v56 offset:512
    ds_read_b64_tr_b16 v[156:157], v56 offset:8192
    ds_read_b64_tr_b16 v[158:159], v56 offset:8704
    s_waitcnt lgkmcnt(10)
    v_mfma_f32_32x32x16_bf16 v[64:79], v[148:151], v[136:139], v[64:79]
    v_mfma_f32_32x32x16_bf16 v[80:95], v[160:163], v[136:139], v[80:95]
    ds_read_b128 v[136:139], v49 offset:512
    ds_read_b64_tr_b16 v[148:149], v56 offset:2048
    ds_read_b64_tr_b16 v[150:151], v56 offset:2560
    ds_read_b64_tr_b16 v[160:161], v56 offset:10240
    ds_read_b64_tr_b16 v[162:163], v56 offset:10752
    s_waitcnt lgkmcnt(10)
    v_mfma_f32_32x32x16_bf16 v[64:79], v[140:143], v[128:131], v[64:79]
    v_mfma_f32_32x32x16_bf16 v[80:95], v[152:155], v[128:131], v[80:95]
    ds_read_b128 v[128:131], v50 offset:512
    ds_read_b64_tr_b16 v[140:141], v56 offset:4096
    ds_read_b64_tr_b16 v[142:143], v56 offset:4608
    ds_read_b64_tr_b16 v[152:153], v56 offset:12288
    ds_read_b64_tr_b16 v[154:155], v56 offset:12800
    s_waitcnt lgkmcnt(10)
    v_mfma_f32_32x32x16_bf16 v[64:79], v[144:147], v[132:135], v[64:79]
    v_mfma_f32_32x32x16_bf16 v[80:95], v[156:159], v[132:135], v[80:95]
    ds_read_b128 v[132:135], v51 offset:512
    ds_read_b64_tr_b16 v[144:145], v56 offset:6144
    ds_read_b64_tr_b16 v[146:147], v56 offset:6656
    ds_read_b64_tr_b16 v[156:157], v56 offset:14336
    ds_read_b64_tr_b16 v[158:159], v56 offset:14848
    s_waitcnt lgkmcnt(10)
    v_mfma_f32_32x32x16_bf16 v[64:79], v[148:151], v[136:139], v[64:79]
    v_mfma_f32_32x32x16_bf16 v[80:95], v[160:163], v[136:139], v[80:95]
    s_waitcnt vmcnt(3)
    s_barrier
    s_add_u32 m0, s50, 73728
    s_mov_b32 s51, 1376256
    buffer_load_dwordx4 v47, s[32:35], s51 offen lds
    s_add_u32 m0, s50, 81920
    s_mov_b32 s51, 1377280
    buffer_load_dwordx4 v47, s[32:35], s51 offen lds
    s_add_u32 m0, s50, 90112
    s_mov_b32 s51, 1378304
    buffer_load_dwordx4 v47, s[32:35], s51 offen lds
    ds_read_b128 v[136:139], v52 offset:512
    ds_read_b64_tr_b16 v[148:149], v56 offset:24576
    ds_read_b64_tr_b16 v[150:151], v56 offset:25088
    ds_read_b64_tr_b16 v[160:161], v56 offset:32768
    ds_read_b64_tr_b16 v[162:163], v56 offset:33280
    s_waitcnt lgkmcnt(10)
    v_mfma_f32_32x32x16_bf16 v[64:79], v[140:143], v[128:131], v[64:79]
    v_mfma_f32_32x32x16_bf16 v[80:95], v[152:155], v[128:131], v[80:95]
    ds_read_b128 v[128:131], v53 offset:512
    ds_read_b64_tr_b16 v[140:141], v56 offset:26624
    ds_read_b64_tr_b16 v[142:143], v56 offset:27136
    ds_read_b64_tr_b16 v[152:153], v56 offset:34816
    ds_read_b64_tr_b16 v[154:155], v56 offset:35328
    s_waitcnt lgkmcnt(10)
    v_mfma_f32_32x32x16_bf16 v[64:79], v[144:147], v[132:135], v[64:79]
    v_mfma_f32_32x32x16_bf16 v[80:95], v[156:159], v[132:135], v[80:95]
    ds_read_b128 v[132:135], v54 offset:512
    ds_read_b64_tr_b16 v[144:145], v56 offset:28672
    ds_read_b64_tr_b16 v[146:147], v56 offset:29184
    ds_read_b64_tr_b16 v[156:157], v56 offset:36864
    ds_read_b64_tr_b16 v[158:159], v56 offset:37376
    s_waitcnt lgkmcnt(10)
    v_mfma_f32_32x32x16_bf16 v[64:79], v[148:151], v[136:139], v[64:79]
    v_mfma_f32_32x32x16_bf16 v[80:95], v[160:163], v[136:139], v[80:95]
    ds_read_b128 v[136:139], v55 offset:512
    ds_read_b64_tr_b16 v[148:149], v56 offset:30720
    ds_read_b64_tr_b16 v[150:151], v56 offset:31232
    ds_read_b64_tr_b16 v[160:161], v56 offset:38912
    ds_read_b64_tr_b16 v[162:163], v56 offset:39424
    s_waitcnt lgkmcnt(10)
    v_mfma_f32_32x32x16_bf16 v[64:79], v[140:143], v[128:131], v[64:79]
    v_mfma_f32_32x32x16_bf16 v[80:95], v[152:155], v[128:131], v[80:95]
    s_waitcnt vmcnt(3)
    s_barrier
    ds_read_b128 v[128:131], v48 offset:768
    ds_read_b64_tr_b16 v[140:141], v57 offset:0
    ds_read_b64_tr_b16 v[142:143], v57 offset:512
    ds_read_b64_tr_b16 v[152:153], v57 offset:8192
    ds_read_b64_tr_b16 v[154:155], v57 offset:8704
    s_waitcnt lgkmcnt(10)
    v_mfma_f32_32x32x16_bf16 v[64:79], v[144:147], v[132:135], v[64:79]
    v_mfma_f32_32x32x16_bf16 v[80:95], v[156:159], v[132:135], v[80:95]
    ds_read_b128 v[132:135], v49 offset:768
    ds_read_b64_tr_b16 v[144:145], v57 offset:2048
    ds_read_b64_tr_b16 v[146:147], v57 offset:2560
    ds_read_b64_tr_b16 v[156:157], v57 offset:10240
    ds_read_b64_tr_b16 v[158:159], v57 offset:10752
    s_waitcnt lgkmcnt(10)
    v_mfma_f32_32x32x16_bf16 v[64:79], v[148:151], v[136:139], v[64:79]
    v_mfma_f32_32x32x16_bf16 v[80:95], v[160:163], v[136:139], v[80:95]
    ds_read_b128 v[136:139], v50 offset:768
    ds_read_b64_tr_b16 v[148:149], v57 offset:4096
    ds_read_b64_tr_b16 v[150:151], v57 offset:4608
    ds_read_b64_tr_b16 v[160:161], v57 offset:12288
    ds_read_b64_tr_b16 v[162:163], v57 offset:12800
    s_waitcnt lgkmcnt(10)
    v_mfma_f32_32x32x16_bf16 v[64:79], v[140:143], v[128:131], v[64:79]
    v_mfma_f32_32x32x16_bf16 v[80:95], v[152:155], v[128:131], v[80:95]
    ds_read_b128 v[128:131], v51 offset:768
    ds_read_b64_tr_b16 v[140:141], v57 offset:6144
    ds_read_b64_tr_b16 v[142:143], v57 offset:6656
    ds_read_b64_tr_b16 v[152:153], v57 offset:14336
    ds_read_b64_tr_b16 v[154:155], v57 offset:14848
    s_waitcnt lgkmcnt(10)
    v_mfma_f32_32x32x16_bf16 v[64:79], v[144:147], v[132:135], v[64:79]
    v_mfma_f32_32x32x16_bf16 v[80:95], v[156:159], v[132:135], v[80:95]
    s_waitcnt vmcnt(0)
    s_barrier
    ds_read_b128 v[132:135], v52 offset:768
    ds_read_b64_tr_b16 v[144:145], v57 offset:24576
    ds_read_b64_tr_b16 v[146:147], v57 offset:25088
    ds_read_b64_tr_b16 v[156:157], v57 offset:32768
    ds_read_b64_tr_b16 v[158:159], v57 offset:33280
    s_waitcnt lgkmcnt(10)
    v_mfma_f32_32x32x16_bf16 v[64:79], v[148:151], v[136:139], v[64:79]
    v_mfma_f32_32x32x16_bf16 v[80:95], v[160:163], v[136:139], v[80:95]
    ds_read_b128 v[136:139], v53 offset:768
    ds_read_b64_tr_b16 v[148:149], v57 offset:26624
    ds_read_b64_tr_b16 v[150:151], v57 offset:27136
    ds_read_b64_tr_b16 v[160:161], v57 offset:34816
    ds_read_b64_tr_b16 v[162:163], v57 offset:35328
    s_waitcnt lgkmcnt(10)
    v_mfma_f32_32x32x16_bf16 v[64:79], v[140:143], v[128:131], v[64:79]
    v_mfma_f32_32x32x16_bf16 v[80:95], v[152:155], v[128:131], v[80:95]
    ds_read_b128 v[128:131], v54 offset:768
    ds_read_b64_tr_b16 v[140:141], v57 offset:28672
    ds_read_b64_tr_b16 v[142:143], v57 offset:29184
    ds_read_b64_tr_b16 v[152:153], v57 offset:36864
    ds_read_b64_tr_b16 v[154:155], v57 offset:37376
    s_waitcnt lgkmcnt(10)
    v_mfma_f32_32x32x16_bf16 v[64:79], v[144:147], v[132:135], v[64:79]
    v_mfma_f32_32x32x16_bf16 v[80:95], v[156:159], v[132:135], v[80:95]
    ds_read_b128 v[132:135], v55 offset:768
    ds_read_b64_tr_b16 v[144:145], v57 offset:30720
    ds_read_b64_tr_b16 v[146:147], v57 offset:31232
    ds_read_b64_tr_b16 v[156:157], v57 offset:38912
    ds_read_b64_tr_b16 v[158:159], v57 offset:39424
    s_waitcnt lgkmcnt(10)
    v_mfma_f32_32x32x16_bf16 v[64:79], v[148:151], v[136:139], v[64:79]
    v_mfma_f32_32x32x16_bf16 v[80:95], v[160:163], v[136:139], v[80:95]
    s_waitcnt lgkmcnt(5)
    v_mfma_f32_32x32x16_bf16 v[64:79], v[140:143], v[128:131], v[64:79]
    v_mfma_f32_32x32x16_bf16 v[80:95], v[152:155], v[128:131], v[80:95]
    s_waitcnt lgkmcnt(0)
    v_mfma_f32_32x32x16_bf16 v[64:79], v[144:147], v[132:135], v[64:79]
    v_mfma_f32_32x32x16_bf16 v[80:95], v[156:159], v[132:135], v[80:95]
    s_lshl_b32 s46, s27, 2
    s_lshl_b32 s47, s45, 1
    s_add_u32 s46, s46, s47
    s_lshl_b32 s47, s26, 1
    s_add_u32 s47, s47, s44
    s_lshl_b32 s48, s46, 16
    s_lshl_b32 s49, s47, 10
    s_add_u32 s48, s48, s49
    v_lshlrev_b32 v1, 4, v0
    s_add_u32 s51, s48, 0x10000
    s_add_u32 s52, s48, 2097152
    s_add_u32 s53, s51, 2097152
    s_mov_b32 s54, 0x3eb8aa3b
    s_nop 7
    v_mul_f32 v64, s54, v64
    v_mul_f32 v65, s54, v65
    v_mul_f32 v66, s54, v66
    v_mul_f32 v67, s54, v67
    v_mul_f32 v68, s54, v68
    v_mul_f32 v69, s54, v69
    v_mul_f32 v70, s54, v70
    v_mul_f32 v71, s54, v71
    v_mul_f32 v72, s54, v72
    v_mul_f32 v73, s54, v73
    v_mul_f32 v74, s54, v74
    v_mul_f32 v75, s54, v75
    v_mul_f32 v76, s54, v76
    v_mul_f32 v77, s54, v77
    v_mul_f32 v78, s54, v78
    v_mul_f32 v79, s54, v79
    v_cvt_pk_bf16_f32 v8, v64, v65
    v_cvt_pk_bf16_f32 v9, v66, v67
    v_cvt_pk_bf16_f32 v10, v68, v69
    v_cvt_pk_bf16_f32 v11, v70, v71
    v_cvt_pk_bf16_f32 v12, v72, v73
    v_cvt_pk_bf16_f32 v13, v74, v75
    v_cvt_pk_bf16_f32 v14, v76, v77
    v_cvt_pk_bf16_f32 v15, v78, v79
    v_cvt_pk_bf16_f32 v16, v80, v81
    v_cvt_pk_bf16_f32 v17, v82, v83
    v_cvt_pk_bf16_f32 v18, v84, v85
    v_cvt_pk_bf16_f32 v19, v86, v87
    v_cvt_pk_bf16_f32 v20, v88, v89
    v_cvt_pk_bf16_f32 v21, v90, v91
    v_cvt_pk_bf16_f32 v22, v92, v93
    v_cvt_pk_bf16_f32 v23, v94, v95
    s_cmp_lg_u32 s3, 0
    s_cbranch_scc1 L_zf_5
    buffer_load_dword v247, v248, s[76:79], 0 offen sc1
L_zf_5:
    buffer_store_dwordx4 v[8:11], v1, s[36:39], s48 offen sc1
    buffer_store_dwordx4 v[12:15], v1, s[36:39], s51 offen sc1
    buffer_store_dwordx4 v[16:19], v1, s[36:39], s52 offen sc1
    buffer_store_dwordx4 v[20:23], v1, s[36:39], s53 offen sc1
    s_branch L_p1_end_4
L_p1_v_3:
    v_mov_b32 v64, 0
    v_mov_b32 v65, 0
    v_mov_b32 v66, 0
    v_mov_b32 v67, 0
    v_mov_b32 v68, 0
    v_mov_b32 v69, 0
    v_mov_b32 v70, 0
    v_mov_b32 v71, 0
    v_mov_b32 v72, 0
    v_mov_b32 v73, 0
    v_mov_b32 v74, 0
    v_mov_b32 v75, 0
    v_mov_b32 v76, 0
    v_mov_b32 v77, 0
    v_mov_b32 v78, 0
    v_mov_b32 v79, 0
    s_waitcnt vmcnt(10) lgkmcnt(0)
    s_barrier
    ds_read_b128 v[128:131], v48 offset:0
    ds_read_b64_tr_b16 v[140:141], v56 offset:16384
    ds_read_b64_tr_b16 v[142:143], v56 offset:16896
    ds_read_b128 v[132:135], v49 offset:0
    ds_read_b64_tr_b16 v[144:145], v56 offset:18432
    ds_read_b64_tr_b16 v[146:147], v56 offset:18944
    ds_read_b128 v[136:139], v50 offset:0
    ds_read_b64_tr_b16 v[148:149], v56 offset:20480
    ds_read_b64_tr_b16 v[150:151], v56 offset:20992
    s_waitcnt lgkmcnt(6)
    v_mfma_f32_32x32x16_bf16 v[64:79], v[128:131], v[140:143], v[64:79]
    ds_read_b128 v[128:131], v51 offset:0
    ds_read_b64_tr_b16 v[140:141], v56 offset:22528
    ds_read_b64_tr_b16 v[142:143], v56 offset:23040
    s_waitcnt lgkmcnt(6)
    v_mfma_f32_32x32x16_bf16 v[64:79], v[132:135], v[144:147], v[64:79]
    s_waitcnt vmcnt(7)
    s_barrier
    ds_read_b128 v[132:135], v52 offset:0
    ds_read_b64_tr_b16 v[144:145], v56 offset:40960
    ds_read_b64_tr_b16 v[146:147], v56 offset:41472
    s_waitcnt lgkmcnt(6)
    v_mfma_f32_32x32x16_bf16 v[64:79], v[136:139], v[148:151], v[64:79]
    ds_read_b128 v[136:139], v53 offset:0
    ds_read_b64_tr_b16 v[148:149], v56 offset:43008
    ds_read_b64_tr_b16 v[150:151], v56 offset:43520
    s_waitcnt lgkmcnt(6)
    v_mfma_f32_32x32x16_bf16 v[64:79], v[128:131], v[140:143], v[64:79]
    ds_read_b128 v[128:131], v54 offset:0
    ds_read_b64_tr_b16 v[140:141], v56 offset:45056
    ds_read_b64_tr_b16 v[142:143], v56 offset:45568
    s_waitcnt lgkmcnt(6)
    v_mfma_f32_32x32x16_bf16 v[64:79], v[132:135], v[144:147], v[64:79]
    ds_read_b128 v[132:135], v55 offset:0
    ds_read_b64_tr_b16 v[144:145], v56 offset:47104
    ds_read_b64_tr_b16 v[146:147], v56 offset:47616
    s_waitcnt lgkmcnt(6)
    v_mfma_f32_32x32x16_bf16 v[64:79], v[136:139], v[148:151], v[64:79]
    s_waitcnt vmcnt(4)
    s_barrier
    s_mov_b32 m0, s50
    s_mov_b32 s51, 786432
    buffer_load_dwordx4 v47, s[32:35], s51 offen lds
    s_add_u32 m0, s50, 8192
    s_mov_b32 s51, 787456
    buffer_load_dwordx4 v47, s[32:35], s51 offen lds
    s_add_u32 m0, s50, 16384
    s_mov_b32 s51, 788480
    buffer_load_dwordx4 v47, s[32:35], s51 offen lds
    ds_read_b128 v[136:139], v48 offset:256
    ds_read_b64_tr_b16 v[148:149], v57 offset:16384
    ds_read_b64_tr_b16 v[150:151], v57 offset:16896
    s_waitcnt lgkmcnt(6)
    v_mfma_f32_32x32x16_bf16 v[64:79], v[128:131], v[140:143], v[64:79]
    ds_read_b128 v[128:131], v49 offset:256
    ds_read_b64_tr_b16 v[140:141], v57 offset:18432
    ds_read_b64_tr_b16 v[142:143], v57 offset:18944
    s_waitcnt lgkmcnt(6)
    v_mfma_f32_32x32x16_bf16 v[64:79], v[132:135], v[144:147], v[64:79]
    ds_read_b128 v[132:135], v50 offset:256
    ds_read_b64_tr_b16 v[144:145], v57 offset:20480
    ds_read_b64_tr_b16 v[146:147], v57 offset:20992
    s_waitcnt lgkmcnt(6)
    v_mfma_f32_32x32x16_bf16 v[64:79], v[136:139], v[148:151], v[64:79]
    ds_read_b128 v[136:139], v51 offset:256
    ds_read_b64_tr_b16 v[148:149], v57 offset:22528
    ds_read_b64_tr_b16 v[150:151], v57 offset:23040
    s_waitcnt lgkmcnt(6)
    v_mfma_f32_32x32x16_bf16 v[64:79], v[128:131], v[140:143], v[64:79]
    s_waitcnt vmcnt(4)
    s_barrier
    s_add_u32 m0, s50, 24576
    s_mov_b32 s51, 983040
    buffer_load_dwordx4 v47, s[32:35], s51 offen lds
    s_add_u32 m0, s50, 32768
    s_mov_b32 s51, 984064
    buffer_load_dwordx4 v47, s[32:35], s51 offen lds
    s_add_u32 m0, s50, 40960
    s_mov_b32 s51, 985088
    buffer_load_dwordx4 v47, s[32:35], s51 offen lds
    ds_read_b128 v[128:131], v52 offset:256
    ds_read_b64_tr_b16 v[140:141], v57 offset:40960
    ds_read_b64_tr_b16 v[142:143], v57 offset:41472
    s_waitcnt lgkmcnt(6)
    v_mfma_f32_32x32x16_bf16 v[64:79], v[132:135], v[144:147], v[64:79]
    ds_read_b128 v[132:135], v53 offset:256
    ds_read_b64_tr_b16 v[144:145], v57 offset:43008
    ds_read_b64_tr_b16 v[146:147], v57 offset:43520
    s_waitcnt lgkmcnt(6)
    v_mfma_f32_32x32x16_bf16 v[64:79], v[136:139], v[148:151], v[64:79]
    ds_read_b128 v[136:139], v54 offset:256
    ds_read_b64_tr_b16 v[148:149], v57 offset:45056
    ds_read_b64_tr_b16 v[150:151], v57 offset:45568
    s_waitcnt lgkmcnt(6)
    v_mfma_f32_32x32x16_bf16 v[64:79], v[128:131], v[140:143], v[64:79]
    ds_read_b128 v[128:131], v55 offset:256
    ds_read_b64_tr_b16 v[140:141], v57 offset:47104
    ds_read_b64_tr_b16 v[142:143], v57 offset:47616
    s_waitcnt lgkmcnt(6)
    v_mfma_f32_32x32x16_bf16 v[64:79], v[132:135], v[144:147], v[64:79]
    s_waitcnt vmcnt(3)
    s_barrier
    s_add_u32 m0, s50, 49152
    s_mov_b32 s51, 1179648
    buffer_load_dwordx4 v47, s[32:35], s51 offen lds
    s_add_u32 m0, s50, 57344
    s_mov_b32 s51, 1180672
    buffer_load_dwordx4 v47, s[32:35], s51 offen lds
    s_add_u32 m0, s50, 65536
    s_mov_b32 s51, 1181696
    buffer_load_dwordx4 v47, s[32:35], s51 offen lds
    ds_read_b128 v[132:135], v48 offset:512
    ds_read_b64_tr_b16 v[144:145], v56 offset:16384
    ds_read_b64_tr_b16 v[146:147], v56 offset:16896
    s_waitcnt lgkmcnt(6)
    v_mfma_f32_32x32x16_bf16 v[64:79], v[136:139], v[148:151], v[64:79]
    ds_read_b128 v[136:139], v49 offset:512
    ds_read_b64_tr_b16 v[148:149], v56 offset:18432
    ds_read_b64_tr_b16 v[150:151], v56 offset:18944
    s_waitcnt lgkmcnt(6)
    v_mfma_f32_32x32x16_bf16 v[64:79], v[128:131], v[140:143], v[64:79]
    ds_read_b128 v[128:131], v50 offset:512
    ds_read_b64_tr_b16 v[140:141], v56 offset:20480
    ds_read_b64_tr_b16 v[142:143], v56 offset:20992
    s_waitcnt lgkmcnt(6)
    v_mfma_f32_32x32x16_bf16 v[64:79], v[132:135], v[144:147], v[64:79]
    ds_read_b128 v[132:135], v51 offset:512
    ds_read_b64_tr_b16 v[144:145], v56 offset:22528
    ds_read_b64_tr_b16 v[146:147], v56 offset:23040
    s_waitcnt lgkmcnt(6)
    v_mfma_f32_32x32x16_bf16 v[64:79], v[136:139], v[148:151], v[64:79]
    s_waitcnt vmcnt(3)
    s_barrier
    s_add_u32 m0, s50, 73728
    s_mov_b32 s51, 1376256
    buffer_load_dwordx4 v47, s[32:35], s51 offen lds
    s_add_u32 m0, s50, 81920
    s_mov_b32 s51, 1377280
    buffer_load_dwordx4 v47, s[32:35], s51 offen lds
    s_add_u32 m0, s50, 90112
    s_mov_b32 s51, 1378304
    buffer_load_dwordx4 v47, s[32:35], s51 offen lds
    ds_read_b128 v[136:139], v52 offset:512
    ds_read_b64_tr_b16 v[148:149], v56 offset:40960
    ds_read_b64_tr_b16 v[150:151], v56 offset:41472
    s_waitcnt lgkmcnt(6)
    v_mfma_f32_32x32x16_bf16 v[64:79], v[128:131], v[140:143], v[64:79]
    ds_read_b128 v[128:131], v53 offset:512
    ds_read_b64_tr_b16 v[140:141], v56 offset:43008
    ds_read_b64_tr_b16 v[142:143], v56 offset:43520
    s_waitcnt lgkmcnt(6)
    v_mfma_f32_32x32x16_bf16 v[64:79], v[132:135], v[144:147], v[64:79]
    ds_read_b128 v[132:135], v54 offset:512
    ds_read_b64_tr_b16 v[144:145], v56 offset:45056
    ds_read_b64_tr_b16 v[146:147], v56 offset:45568
    s_waitcnt lgkmcnt(6)
    v_mfma_f32_32x32x16_bf16 v[64:79], v[136:139], v[148:151], v[64:79]
    ds_read_b128 v[136:139], v55 offset:512
    ds_read_b64_tr_b16 v[148:149], v56 offset:47104
    ds_read_b64_tr_b16 v[150:151], v56 offset:47616
    s_waitcnt lgkmcnt(6)
    v_mfma_f32_32x32x16_bf16 v[64:79], v[128:131], v[140:143], v[64:79]
    s_waitcnt vmcnt(3)
    s_barrier
    ds_read_b128 v[128:131], v48 offset:768
    ds_read_b64_tr_b16 v[140:141], v57 offset:16384
    ds_read_b64_tr_b16 v[142:143], v57 offset:16896
    s_waitcnt lgkmcnt(6)
    v_mfma_f32_32x32x16_bf16 v[64:79], v[132:135], v[144:147], v[64:79]
    ds_read_b128 v[132:135], v49 offset:768
    ds_read_b64_tr_b16 v[144:145], v57 offset:18432
    ds_read_b64_tr_b16 v[146:147], v57 offset:18944
    s_waitcnt lgkmcnt(6)
    v_mfma_f32_32x32x16_bf16 v[64:79], v[136:139], v[148:151], v[64:79]
    ds_read_b128 v[136:139], v50 offset:768
    ds_read_b64_tr_b16 v[148:149], v57 offset:20480
    ds_read_b64_tr_b16 v[150:151], v57 offset:20992
    s_waitcnt lgkmcnt(6)
    v_mfma_f32_32x32x16_bf16 v[64:79], v[128:131], v[140:143], v[64:79]
    ds_read_b128 v[128:131], v51 offset:768
    ds_read_b64_tr_b16 v[140:141], v57 offset:22528
    ds_read_b64_tr_b16 v[142:143], v57 offset:23040
    s_waitcnt lgkmcnt(6)
    v_mfma_f32_32x32x16_bf16 v[64:79], v[132:135], v[144:147], v[64:79]
    s_waitcnt vmcnt(0)
    s_barrier
    ds_read_b128 v[132:135], v52 offset:768
    ds_read_b64_tr_b16 v[144:145], v57 offset:40960
    ds_read_b64_tr_b16 v[146:147], v57 offset:41472
    s_waitcnt lgkmcnt(6)
    v_mfma_f32_32x32x16_bf16 v[64:79], v[136:139], v[148:151], v[64:79]
    ds_read_b128 v[136:139], v53 offset:768
    ds_read_b64_tr_b16 v[148:149], v57 offset:43008
    ds_read_b64_tr_b16 v[150:151], v57 offset:43520
    s_waitcnt lgkmcnt(6)
    v_mfma_f32_32x32x16_bf16 v[64:79], v[128:131], v[140:143], v[64:79]
    ds_read_b128 v[128:131], v54 offset:768
    ds_read_b64_tr_b16 v[140:141], v57 offset:45056
    ds_read_b64_tr_b16 v[142:143], v57 offset:45568
    s_waitcnt lgkmcnt(6)
    v_mfma_f32_32x32x16_bf16 v[64:79], v[132:135], v[144:147], v[64:79]
    ds_read_b128 v[132:135], v55 offset:768
    ds_read_b64_tr_b16 v[144:145], v57 offset:47104
    ds_read_b64_tr_b16 v[146:147], v57 offset:47616
    s_waitcnt lgkmcnt(6)
    v_mfma_f32_32x32x16_bf16 v[64:79], v[136:139], v[148:151], v[64:79]
    s_waitcnt lgkmcnt(3)
    v_mfma_f32_32x32x16_bf16 v[64:79], v[128:131], v[140:143], v[64:79]
    s_waitcnt lgkmcnt(0)
    v_mfma_f32_32x32x16_bf16 v[64:79], v[132:135], v[144:147], v[64:79]
    s_lshl_b32 s46, s27, 2
    s_lshl_b32 s47, s45, 1
    s_add_u32 s46, s46, s47
    s_lshl_b32 s47, s26, 1
    s_add_u32 s47, s47, s44
    s_lshl_b32 s48, s46, 16
    s_lshl_b32 s49, s47, 10
    s_add_u32 s48, s48, s49
    s_add_u32 s48, s48, 4194304
    v_bfe_u32 v1, v0, 4, 1
    v_lshlrev_b32 v1, 16, v1
    v_lshrrev_b32 v2, 5, v0
    v_lshlrev_b32 v2, 8, v2
    v_add_u32 v1, v1, v2
    v_and_b32 v2, 15, v0
    v_lshlrev_b32 v2, 4, v2
    v_add_u32 v1, v1, v2
    s_nop 7
    v_cvt_pk_bf16_f32 v8, v64, v65
    v_cvt_pk_bf16_f32 v9, v66, v67
    v_cvt_pk_bf16_f32 v10, v68, v69
    v_cvt_pk_bf16_f32 v11, v70, v71
    v_cvt_pk_bf16_f32 v12, v72, v73
    v_cvt_pk_bf16_f32 v13, v74, v75
    v_cvt_pk_bf16_f32 v14, v76, v77
    v_cvt_pk_bf16_f32 v15, v78, v79
    s_cmp_lg_u32 s3, 0
    s_cbranch_scc1 L_zf_6
    buffer_load_dword v247, v248, s[76:79], 0 offen sc1
L_zf_6:
    buffer_store_dwordx4 v[8:11], v1, s[36:39], s48 offen sc1
    buffer_store_dwordx4 v[12:15], v1, s[36:39], s48 offen offset:512 sc1
L_p1_end_4:
    s_cmp_lg_u32 s3, 0
    s_cbranch_scc1 L_zc_7
    s_mov_b32 s61, 0
L_zp_8:
    s_waitcnt vmcnt(0)
    v_readfirstlane_b32 s64, v247
    s_add_u32 s61, s61, 1
    s_cmp_lg_u32 s64, 0
    s_cbranch_scc1 L_zc_7
    buffer_load_dword v247, v248, s[76:79], 0 offen sc1
    s_cmp_lt_u32 s61, 0x200000
    s_cbranch_scc1 L_zp_8
L_zc_7:
    s_waitcnt vmcnt(0)
    s_barrier
    s_cmp_lg_u32 s3, 0
    s_cbranch_scc1 L_arr_9
    s_lshl_b32 s60, s27, 8
    s_add_u32 s60, s60, 14942208
    v_mov_b32 v250, 1
    v_mov_b32 v251, 0
    v_cmp_eq_u32 vcc, 0, v0
    s_and_saveexec_b64 s[62:63], vcc
    buffer_atomic_add v250, v251, s[68:71], s60 offen
    s_mov_b64 exec, s[62:63]
L_arr_9:
    s_and_b32 s46, s2, 7
    s_lshr_b32 s47, s2, 3
    s_lshl_b32 s48, s46, 2
    s_lshr_b32 s49, s47, 3
    s_add_u32 s26, s48, s49
    s_and_b32 s27, s47, 7
    s_mov_b32 s36, s24
    s_mov_b32 s37, s25
    s_mov_b32 s38, 0x1000000
    s_mov_b32 s39, 0x20000
    v_lshlrev_b32 v1, 4, v0
    s_lshl_b32 s46, s26, 16
    s_lshl_b32 s47, s27, 3
    s_add_u32 s47, s47, s3
    s_lshl_b32 s47, s47, 10
    s_add_u32 s47, s47, s46
    s_lshl_b32 s48, s3, 11
    s_add_u32 s49, s46, s48
    s_mov_b32 s56, 0x0000ffff
    s_mov_b32 s57, 0x0000ffff
    v_and_b32 v2, 27, v0
    v_cmp_eq_u32 vcc, 16, v2
    v_mov_b32 v3, 0x3f803f80
    v_mov_b32 v2, 0
    v_cndmask_b32 v2, v2, v3, vcc
    v_mov_b32 v16, v2
    v_mov_b32 v17, v2
    v_mov_b32 v18, v2
    v_mov_b32 v19, v2
    v_mov_b32 v20, v2
    v_mov_b32 v21, v2
    v_mov_b32 v22, v2
    v_mov_b32 v23, v2
    v_mov_b32 v24, v2
    v_mov_b32 v25, v2
    v_mov_b32 v26, v2
    v_mov_b32 v27, v2
    v_mov_b32 v28, v2
    v_mov_b32 v29, v2
    v_mov_b32 v30, v2
    v_mov_b32 v31, v2
    v_and_b32 v2, 15, v0
    v_lshlrev_b32 v2, 4, v2
    v_lshrrev_b32 v3, 5, v0
    v_lshlrev_b32 v3, 8, v3
    v_add_u32 v91, v2, v3
    v_add_u32 v91, 0x10000, v91
    s_mov_b32 s28, s12
    s_mov_b32 s29, s13
    s_mov_b32 s30, 0x700000
    s_mov_b32 s31, 0x20000
    s_mov_b32 s32, s16
    s_mov_b32 s33, s17
    s_mov_b32 s34, 0x700000
    s_mov_b32 s35, 0x20000
    s_mov_b32 s40, s8
    s_mov_b32 s41, s9
    s_mov_b32 s42, 0x80000
    s_mov_b32 s43, 0x20000
    v_and_b32 v112, 7, v0
    v_lshlrev_b32 v112, 8, v112
    v_mov_b32 v113, 0
    v_lshrrev_b32 v2, 3, v0
    s_mov_b32 s65, 3584
    v_mul_lo_u32 v92, v2, s65
    v_bfe_u32 v2, v0, 4, 1
    v_lshlrev_b32 v2, 2, v2
    v_and_b32 v3, 7, v0
    v_xor_b32 v2, v2, v3
    v_lshlrev_b32 v2, 4, v2
    v_add_u32 v92, v92, v2
    s_mul_i32 s60, s3, 917504
    s_add_u32 s60, s60, s99
    v_add_u32 v92, s60, v92
    v_add_u32 v117, 27648, v92
    v_add_u32 v118, 55296, v92
    v_add_u32 v119, 82944, v92
    v_lshrrev_b32 v2, 5, v0
    v_lshlrev_b32 v2, 2, v2
    v_bfe_u32 v3, v0, 2, 2
    v_add_u32 v2, v2, v3
    v_lshlrev_b32 v93, 7, v2
    v_bfe_u32 v2, v0, 4, 1
    v_lshlrev_b32 v2, 1, v2
    v_bfe_u32 v3, v0, 1, 1
    v_add_u32 v2, v2, v3
    v_bfe_u32 v3, v0, 3, 1
    v_lshlrev_b32 v3, 2, v3
    v_xor_b32 v2, v2, v3
    v_lshlrev_b32 v2, 4, v2
    v_add_u32 v93, v93, v2
    v_and_b32 v2, 1, v0
    v_lshlrev_b32 v2, 3, v2
    v_add_u32 v93, v93, v2
    s_lshl_b32 s59, s3, 12
    s_add_u32 s59, s59, 131072
    v_add_u32 v93, s59, v93
    v_xor_b32 v94, 64, v93
    s_and_b32 s60, s2, 7
    s_lshr_b32 s61, s2, 3
    v_lshrrev_b32 v2, 3, v0
    s_mov_b32 s65, 1024
    v_mul_lo_u32 v95, v2, s65
    v_bfe_u32 v2, v0, 4, 1
    v_lshlrev_b32 v2, 2, v2
    v_and_b32 v3, 7, v0
    v_xor_b32 v2, v2, v3
    v_lshlrev_b32 v2, 4, v2
    v_add_u32 v95, v95, v2
    s_and_b32 s62, s61, 7
    s_lshl_b32 s62, s62, 7
    s_lshl_b32 s63, s3, 16
    s_add_u32 s62, s62, s63
    v_add_u32 v95, s62, v95
    s_and_b32 s62, s3, 3
    s_lshl_b32 s62, s62, 13
    s_lshr_b32 s63, s3, 2
    s_lshl_b32 s63, s63, 16
    s_add_u32 s53, s62, s63
    s_and_b32 s62, s61, 3
    s_lshl_b32 s62, s62, 6
    s_lshl_b32 s63, s3, 8
    s_add_u32 s62, s62, s63
    v_add_u32 v116, s62, v0
    s_movk_i32 s63, 3584
    v_mul_lo_u32 v116, v116, s63
    v_add_u32 v116, s99, v116
    s_lshl_b32 s62, s60, 2
    s_lshr_b32 s63, s61, 3
    s_add_u32 s62, s62, s63
    s_lshl_b32 s62, s62, 7
    s_and_b32 s63, s61, 7
    s_mul_i32 s63, s63, 224
    s_mul_i32 s64, s3, 28
    s_add_u32 s63, s63, s64
    v_min_u32 v96, 27, v0
    v_add_u32 v96, s63, v96
    v_lshlrev_b32 v96, 12, v96
    v_add_u32 v96, s62, v96
    s_and_b32 s65, s2, 7
    s_cmp_lg_u32 s3, 0
    s_cbranch_scc1 L_wait_10
    s_lshl_b32 s60, s65, 8
    s_add_u32 s60, s60, 14942208
    v_mov_b32 v251, 0
    s_mov_b32 s61, 0
L_poll_11:
    buffer_load_dword v250, v251, s[68:71], s60 offen sc1
    s_waitcnt vmcnt(0)
    v_readfirstlane_b32 s64, v250
    s_add_u32 s61, s61, 1
    s_cmp_ge_u32 s64, 32
    s_cbranch_scc1 L_wait_10
    s_cmp_lt_u32 s61, 0x200000
    s_cbranch_scc1 L_poll_11
L_wait_10:
    s_barrier
    buffer_load_dwordx4 v[4:7], v1, s[36:39], s47 offen sc1
    s_mov_b32 m0, s48
    s_add_u32 s50, s49, 2097152
    buffer_load_dwordx4 v1, s[36:39], s50 offen sc1 lds
    buffer_load_dwordx4 v1, s[36:39], s50 offen offset:1024 sc1 lds
    s_add_u32 m0, s48, 65536
    s_add_u32 s50, s49, 4194304
    buffer_load_dwordx4 v1, s[36:39], s50 offen sc1 lds
    buffer_load_dwordx4 v1, s[36:39], s50 offen offset:1024 sc1 lds
    s_add_u32 m0, s48, 16384
    s_add_u32 s50, s49, 2113536
    buffer_load_dwordx4 v1, s[36:39], s50 offen sc1 lds
    buffer_load_dwordx4 v1, s[36:39], s50 offen offset:1024 sc1 lds
    s_add_u32 m0, s48, 81920
    s_add_u32 s50, s49, 4210688
    buffer_load_dwordx4 v1, s[36:39], s50 offen sc1 lds
    buffer_load_dwordx4 v1, s[36:39], s50 offen offset:1024 sc1 lds
    s_add_u32 m0, s48, 32768
    s_add_u32 s50, s49, 2129920
    buffer_load_dwordx4 v1, s[36:39], s50 offen sc1 lds
    buffer_load_dwordx4 v1, s[36:39], s50 offen offset:1024 sc1 lds
    s_add_u32 m0, s48, 98304
    s_add_u32 s50, s49, 4227072
    buffer_load_dwordx4 v1, s[36:39], s50 offen sc1 lds
    buffer_load_dwordx4 v1, s[36:39], s50 offen offset:1024 sc1 lds
    s_add_u32 m0, s48, 49152
    s_add_u32 s50, s49, 2146304
    buffer_load_dwordx4 v1, s[36:39], s50 offen sc1 lds
    buffer_load_dwordx4 v1, s[36:39], s50 offen offset:1024 sc1 lds
    s_add_u32 m0, s48, 114688
    s_add_u32 s50, s49, 4243456
    buffer_load_dwordx4 v1, s[36:39], s50 offen sc1 lds
    buffer_load_dwordx4 v1, s[36:39], s50 offen offset:1024 sc1 lds
    s_waitcnt vmcnt(12)
    s_barrier
L_att_code:
    v_mov_b32 v88, v1
    v_mov_b32 v89, v91
    ds_read_b128 v[8:11], v88
    s_mov_b64 exec, s[56:57]
    ds_read_b128 v[16:19], v89 offset:0
    ds_read_b128 v[20:23], v89 offset:512
    s_mov_b64 exec, -1
    ds_read_b128 v[12:15], v88 offset:1024
    v_mov_b32 v72, 0
    v_mov_b32 v73, 0
    v_mov_b32 v74, 0
    v_mov_b32 v75, 0
    v_mov_b32 v76, 0
    v_mov_b32 v77, 0
    v_mov_b32 v78, 0
    v_mov_b32 v79, 0
    v_mov_b32 v80, 0
    v_mov_b32 v81, 0
    v_mov_b32 v82, 0
    v_mov_b32 v83, 0
    v_mov_b32 v84, 0
    v_mov_b32 v85, 0
    v_mov_b32 v86, 0
    v_mov_b32 v87, 0
    v_mov_b32 v68, 0
    v_mov_b32 v69, 0
    v_mov_b32 v70, 0
    v_mov_b32 v71, 0
    s_mov_b64 exec, s[56:57]
    v_mov_b32 v28, 0
    v_mov_b32 v29, 0
    v_mov_b32 v30, 0
    v_mov_b32 v31, 0
    s_mov_b64 exec, -1
    s_waitcnt lgkmcnt(3)
    v_mfma_f32_32x32x16_bf16 v[32:47], v[8:11], v[4:7], 0
    s_nop 7
    s_nop 3
    s_mov_b32 m0, s59
    s_mov_b32 s60, 0
    buffer_load_dwordx4 v92, s[28:31], s60 offen lds
    buffer_load_dwordx4 v117, s[28:31], s60 offen offset:1024 lds
    buffer_load_dwordx4 v118, s[28:31], s60 offen offset:2048 lds
    buffer_load_dwordx4 v119, s[28:31], s60 offen offset:3072 lds
    v_exp_f32 v32, v32
    v_exp_f32 v33, v33
    v_mfma_f32_32x32x16_bf16 v[72:87], v[28:31], v[68:71], v[72:87]
    s_mov_b64 exec, s[56:57]
    ds_read_b128 v[24:27], v89 offset:1024
    ds_read_b128 v[28:31], v89 offset:1536
    s_mov_b64 exec, -1
    ds_read_b128 v[8:11], v88 offset:2048
    v_exp_f32 v34, v34
    v_exp_f32 v35, v35
    v_exp_f32 v36, v36
    v_exp_f32 v37, v37
    s_waitcnt lgkmcnt(3)
    v_mfma_f32_32x32x16_bf16 v[48:63], v[12:15], v[4:7], 0
    s_setprio 1
    v_exp_f32 v38, v38
    v_exp_f32 v39, v39
    v_cvt_pk_bf16_f32 v64, v32, v33
    v_cvt_pk_bf16_f32 v65, v34, v35
    v_cvt_pk_bf16_f32 v66, v36, v37
    v_cvt_pk_bf16_f32 v67, v38, v39
    v_exp_f32 v40, v40
    v_exp_f32 v41, v41
    v_mfma_f32_32x32x16_bf16 v[72:87], v[16:19], v[64:67], v[72:87]
    s_setprio 0
    v_exp_f32 v42, v42
    v_exp_f32 v43, v43
    v_exp_f32 v44, v44
    v_exp_f32 v45, v45
    v_exp_f32 v46, v46
    v_exp_f32 v47, v47
    v_cvt_pk_bf16_f32 v68, v40, v41
    v_cvt_pk_bf16_f32 v69, v42, v43
    v_cvt_pk_bf16_f32 v70, v44, v45
    v_cvt_pk_bf16_f32 v71, v46, v47
    v_mov_b32 v120, -1
    v_mov_b32 v121, -1
    v_mov_b32 v122, -1
    v_mov_b32 v123, -1
    v_mov_b32 v124, v1
    buffer_store_dwordx4 v[120:123], v124, s[68:71], s96 offen sc1
    buffer_store_dwordx4 v[120:123], v124, s[68:71], s97 offen sc1
    s_cmp_eq_u32 s100, 0
    s_cselect_b32 s60, s97, s98
    buffer_store_dwordx4 v[120:123], v124, s[68:71], s60 offen sc1
    s_lshl_b32 s60, s2, 9
    s_lshl_b32 s61, s3, 6
    s_add_u32 s60, s60, s61
    s_add_u32 s60, s60, 14680064
    v_cmp_gt_u32 vcc, 4, v0
    s_and_saveexec_b64 s[62:63], vcc
    buffer_store_dwordx4 v[120:123], v124, s[68:71], s60 offen sc1
    s_mov_b64 exec, s[62:63]
    v_exp_f32 v48, v48
    v_exp_f32 v49, v49
    v_mfma_f32_32x32x16_bf16 v[72:87], v[20:23], v[68:71], v[72:87]
    s_mov_b64 exec, s[56:57]
    ds_read_b128 v[16:19], v89 offset:2048
    ds_read_b128 v[20:23], v89 offset:2560
    s_mov_b64 exec, -1
    ds_read_b128 v[12:15], v88 offset:3072
    v_exp_f32 v50, v50
    v_exp_f32 v51, v51
    v_exp_f32 v52, v52
    v_exp_f32 v53, v53
    s_waitcnt lgkmcnt(3)
    v_mfma_f32_32x32x16_bf16 v[32:47], v[8:11], v[4:7], 0
    s_setprio 1
    v_exp_f32 v54, v54
    v_exp_f32 v55, v55
    v_cvt_pk_bf16_f32 v64, v48, v49
    v_cvt_pk_bf16_f32 v65, v50, v51
    v_cvt_pk_bf16_f32 v66, v52, v53
    v_cvt_pk_bf16_f32 v67, v54, v55
    v_exp_f32 v56, v56
    v_exp_f32 v57, v57
    v_mfma_f32_32x32x16_bf16 v[72:87], v[24:27], v[64:67], v[72:87]
    s_setprio 0
    v_exp_f32 v58, v58
    v_exp_f32 v59, v59
    v_exp_f32 v60, v60
    v_exp_f32 v61, v61
    v_exp_f32 v62, v62
    v_exp_f32 v63, v63
    v_cvt_pk_bf16_f32 v68, v56, v57
    v_cvt_pk_bf16_f32 v69, v58, v59
    v_cvt_pk_bf16_f32 v70, v60, v61
    v_cvt_pk_bf16_f32 v71, v62, v63
    v_exp_f32 v32, v32
    v_exp_f32 v33, v33
    v_mfma_f32_32x32x16_bf16 v[72:87], v[28:31], v[68:71], v[72:87]
    s_mov_b64 exec, s[56:57]
    ds_read_b128 v[24:27], v89 offset:3072
    ds_read_b128 v[28:31], v89 offset:3584
    s_mov_b64 exec, -1
    ds_read_b128 v[8:11], v88 offset:4096
    v_exp_f32 v34, v34
    v_exp_f32 v35, v35
    v_exp_f32 v36, v36
    v_exp_f32 v37, v37
    s_waitcnt lgkmcnt(3)
    v_mfma_f32_32x32x16_bf16 v[48:63], v[12:15], v[4:7], 0
    s_setprio 1
    v_exp_f32 v38, v38
    v_exp_f32 v39, v39
    v_cvt_pk_bf16_f32 v64, v32, v33
    v_cvt_pk_bf16_f32 v65, v34, v35
    v_cvt_pk_bf16_f32 v66, v36, v37
    v_cvt_pk_bf16_f32 v67, v38, v39
    v_exp_f32 v40, v40
    v_exp_f32 v41, v41
    v_mfma_f32_32x32x16_bf16 v[72:87], v[16:19], v[64:67], v[72:87]
    s_setprio 0
    v_exp_f32 v42, v42
    v_exp_f32 v43, v43
    v_exp_f32 v44, v44
    v_exp_f32 v45, v45
    v_exp_f32 v46, v46
    v_exp_f32 v47, v47
    v_cvt_pk_bf16_f32 v68, v40, v41
    v_cvt_pk_bf16_f32 v69, v42, v43
    v_cvt_pk_bf16_f32 v70, v44, v45
    v_cvt_pk_bf16_f32 v71, v46, v47
    v_exp_f32 v48, v48
    v_exp_f32 v49, v49
    v_mfma_f32_32x32x16_bf16 v[72:87], v[20:23], v[68:71], v[72:87]
    s_mov_b64 exec, s[56:57]
    ds_read_b128 v[16:19], v89 offset:4096
    ds_read_b128 v[20:23], v89 offset:4608
    s_mov_b64 exec, -1
    ds_read_b128 v[12:15], v88 offset:5120
    v_exp_f32 v50, v50
    v_exp_f32 v51, v51
    v_exp_f32 v52, v52
    v_exp_f32 v53, v53
    s_waitcnt lgkmcnt(3)
    v_mfma_f32_32x32x16_bf16 v[32:47], v[8:11], v[4:7], 0
    s_setprio 1
    v_exp_f32 v54, v54
    v_exp_f32 v55, v55
    v_cvt_pk_bf16_f32 v64, v48, v49
    v_cvt_pk_bf16_f32 v65, v50, v51
    v_cvt_pk_bf16_f32 v66, v52, v53
    v_cvt_pk_bf16_f32 v67, v54, v55
    v_exp_f32 v56, v56
    v_exp_f32 v57, v57
    v_mfma_f32_32x32x16_bf16 v[72:87], v[24:27], v[64:67], v[72:87]
    s_setprio 0
    v_exp_f32 v58, v58
    v_exp_f32 v59, v59
    v_exp_f32 v60, v60
    v_exp_f32 v61, v61
    v_exp_f32 v62, v62
    v_exp_f32 v63, v63
    v_cvt_pk_bf16_f32 v68, v56, v57
    v_cvt_pk_bf16_f32 v69, v58, v59
    v_cvt_pk_bf16_f32 v70, v60, v61
    v_cvt_pk_bf16_f32 v71, v62, v63
    v_exp_f32 v32, v32
    v_exp_f32 v33, v33
    v_mfma_f32_32x32x16_bf16 v[72:87], v[28:31], v[68:71], v[72:87]
    s_mov_b64 exec, s[56:57]
    ds_read_b128 v[24:27], v89 offset:5120
    ds_read_b128 v[28:31], v89 offset:5632
    s_mov_b64 exec, -1
    ds_read_b128 v[8:11], v88 offset:6144
    v_exp_f32 v34, v34
    v_exp_f32 v35, v35
    v_exp_f32 v36, v36
    v_exp_f32 v37, v37
    s_waitcnt lgkmcnt(3)
    v_mfma_f32_32x32x16_bf16 v[48:63], v[12:15], v[4:7], 0
    s_setprio 1
    v_exp_f32 v38, v38
    v_exp_f32 v39, v39
    v_cvt_pk_bf16_f32 v64, v32, v33
    v_cvt_pk_bf16_f32 v65, v34, v35
    v_cvt_pk_bf16_f32 v66, v36, v37
    v_cvt_pk_bf16_f32 v67, v38, v39
    v_exp_f32 v40, v40
    v_exp_f32 v41, v41
    v_mfma_f32_32x32x16_bf16 v[72:87], v[16:19], v[64:67], v[72:87]
    s_setprio 0
    v_exp_f32 v42, v42
    v_exp_f32 v43, v43
    v_exp_f32 v44, v44
    v_exp_f32 v45, v45
    v_exp_f32 v46, v46
    v_exp_f32 v47, v47
    v_cvt_pk_bf16_f32 v68, v40, v41
    v_cvt_pk_bf16_f32 v69, v42, v43
    v_cvt_pk_bf16_f32 v70, v44, v45
    v_cvt_pk_bf16_f32 v71, v46, v47
    v_exp_f32 v48, v48
    v_exp_f32 v49, v49
    v_mfma_f32_32x32x16_bf16 v[72:87], v[20:23], v[68:71], v[72:87]
    s_mov_b64 exec, s[56:57]
    ds_read_b128 v[16:19], v89 offset:6144
    ds_read_b128 v[20:23], v89 offset:6656
    s_mov_b64 exec, -1
    ds_read_b128 v[12:15], v88 offset:7168
    v_exp_f32 v50, v50
    v_exp_f32 v51, v51
    v_exp_f32 v52, v52
    v_exp_f32 v53, v53
    s_waitcnt lgkmcnt(3)
    v_mfma_f32_32x32x16_bf16 v[32:47], v[8:11], v[4:7], 0
    s_setprio 1
    v_exp_f32 v54, v54
    v_exp_f32 v55, v55
    v_cvt_pk_bf16_f32 v64, v48, v49
    v_cvt_pk_bf16_f32 v65, v50, v51
    v_cvt_pk_bf16_f32 v66, v52, v53
    v_cvt_pk_bf16_f32 v67, v54, v55
    v_exp_f32 v56, v56
    v_exp_f32 v57, v57
    v_mfma_f32_32x32x16_bf16 v[72:87], v[24:27], v[64:67], v[72:87]
    s_setprio 0
    v_exp_f32 v58, v58
    v_exp_f32 v59, v59
    v_exp_f32 v60, v60
    v_exp_f32 v61, v61
    v_exp_f32 v62, v62
    v_exp_f32 v63, v63
    v_cvt_pk_bf16_f32 v68, v56, v57
    v_cvt_pk_bf16_f32 v69, v58, v59
    v_cvt_pk_bf16_f32 v70, v60, v61
    v_cvt_pk_bf16_f32 v71, v62, v63
    v_exp_f32 v32, v32
    v_exp_f32 v33, v33
    v_mfma_f32_32x32x16_bf16 v[72:87], v[28:31], v[68:71], v[72:87]
    s_mov_b64 exec, s[56:57]
    ds_read_b128 v[24:27], v89 offset:7168
    ds_read_b128 v[28:31], v89 offset:7680
    s_mov_b64 exec, -1
    ds_read_b128 v[8:11], v88 offset:8192
    v_exp_f32 v34, v34
    v_exp_f32 v35, v35
    v_exp_f32 v36, v36
    v_exp_f32 v37, v37
    s_waitcnt lgkmcnt(3)
    v_mfma_f32_32x32x16_bf16 v[48:63], v[12:15], v[4:7], 0
    s_setprio 1
    v_exp_f32 v38, v38
    v_exp_f32 v39, v39
    v_cvt_pk_bf16_f32 v64, v32, v33
    v_cvt_pk_bf16_f32 v65, v34, v35
    v_cvt_pk_bf16_f32 v66, v36, v37
    v_cvt_pk_bf16_f32 v67, v38, v39
    v_exp_f32 v40, v40
    v_exp_f32 v41, v41
    v_mfma_f32_32x32x16_bf16 v[72:87], v[16:19], v[64:67], v[72:87]
    s_setprio 0
    v_exp_f32 v42, v42
    v_exp_f32 v43, v43
    v_exp_f32 v44, v44
    v_exp_f32 v45, v45
    v_exp_f32 v46, v46
    v_exp_f32 v47, v47
    v_cvt_pk_bf16_f32 v68, v40, v41
    v_cvt_pk_bf16_f32 v69, v42, v43
    v_cvt_pk_bf16_f32 v70, v44, v45
    v_cvt_pk_bf16_f32 v71, v46, v47
    s_waitcnt vmcnt(4)
    ds_read_b64_tr_b16 v[128:129], v93 offset:0
    ds_read_b64_tr_b16 v[130:131], v93 offset:1024
    ds_read_b64_tr_b16 v[132:133], v94 offset:0
    ds_read_b64_tr_b16 v[134:135], v94 offset:1024
    ds_read_b64_tr_b16 v[136:137], v93 offset:2048
    ds_read_b64_tr_b16 v[138:139], v93 offset:3072
    ds_read_b64_tr_b16 v[140:141], v94 offset:2048
    ds_read_b64_tr_b16 v[142:143], v94 offset:3072
    v_exp_f32 v48, v48
    v_exp_f32 v49, v49
    v_mfma_f32_32x32x16_bf16 v[72:87], v[20:23], v[68:71], v[72:87]
    s_mov_b64 exec, s[56:57]
    ds_read_b128 v[16:19], v89 offset:8192
    ds_read_b128 v[20:23], v89 offset:8704
    s_mov_b64 exec, -1
    ds_read_b128 v[12:15], v88 offset:9216
    v_exp_f32 v50, v50
    v_exp_f32 v51, v51
    v_exp_f32 v52, v52
    v_exp_f32 v53, v53
    s_waitcnt lgkmcnt(3)
    v_mfma_f32_32x32x16_bf16 v[32:47], v[8:11], v[4:7], 0
    s_setprio 1
    v_exp_f32 v54, v54
    v_exp_f32 v55, v55
    v_cvt_pk_bf16_f32 v64, v48, v49
    v_cvt_pk_bf16_f32 v65, v50, v51
    v_cvt_pk_bf16_f32 v66, v52, v53
    v_cvt_pk_bf16_f32 v67, v54, v55
    v_exp_f32 v56, v56
    v_exp_f32 v57, v57
    v_mfma_f32_32x32x16_bf16 v[72:87], v[24:27], v[64:67], v[72:87]
    s_setprio 0
    v_exp_f32 v58, v58
    v_exp_f32 v59, v59
    v_exp_f32 v60, v60
    v_exp_f32 v61, v61
    v_exp_f32 v62, v62
    v_exp_f32 v63, v63
    v_cvt_pk_bf16_f32 v68, v56, v57
    v_cvt_pk_bf16_f32 v69, v58, v59
    v_cvt_pk_bf16_f32 v70, v60, v61
    v_cvt_pk_bf16_f32 v71, v62, v63
    s_mov_b32 m0, s59
    s_mov_b32 s60, 114688
    buffer_load_dwordx4 v92, s[28:31], s60 offen lds
    buffer_load_dwordx4 v117, s[28:31], s60 offen offset:1024 lds
    buffer_load_dwordx4 v118, s[28:31], s60 offen offset:2048 lds
    buffer_load_dwordx4 v119, s[28:31], s60 offen offset:3072 lds
    v_exp_f32 v32, v32
    v_exp_f32 v33, v33
    v_mfma_f32_32x32x16_bf16 v[72:87], v[28:31], v[68:71], v[72:87]
    s_mov_b64 exec, s[56:57]
    ds_read_b128 v[24:27], v89 offset:9216
    ds_read_b128 v[28:31], v89 offset:9728
    s_mov_b64 exec, -1
    ds_read_b128 v[8:11], v88 offset:10240
    v_exp_f32 v34, v34
    v_exp_f32 v35, v35
    v_exp_f32 v36, v36
    v_exp_f32 v37, v37
    s_waitcnt lgkmcnt(3)
    v_mfma_f32_32x32x16_bf16 v[48:63], v[12:15], v[4:7], 0
    s_setprio 1
    v_exp_f32 v38, v38
    v_exp_f32 v39, v39
    v_cvt_pk_bf16_f32 v64, v32, v33
    v_cvt_pk_bf16_f32 v65, v34, v35
    v_cvt_pk_bf16_f32 v66, v36, v37
    v_cvt_pk_bf16_f32 v67, v38, v39
    v_exp_f32 v40, v40
    v_exp_f32 v41, v41
    v_mfma_f32_32x32x16_bf16 v[72:87], v[16:19], v[64:67], v[72:87]
    s_setprio 0
    v_exp_f32 v42, v42
    v_exp_f32 v43, v43
    v_exp_f32 v44, v44
    v_exp_f32 v45, v45
    v_exp_f32 v46, v46
    v_exp_f32 v47, v47
    v_cvt_pk_bf16_f32 v68, v40, v41
    v_cvt_pk_bf16_f32 v69, v42, v43
    v_cvt_pk_bf16_f32 v70, v44, v45
    v_cvt_pk_bf16_f32 v71, v46, v47
    v_exp_f32 v48, v48
    v_exp_f32 v49, v49
    v_mfma_f32_32x32x16_bf16 v[72:87], v[20:23], v[68:71], v[72:87]
    s_mov_b64 exec, s[56:57]
    ds_read_b128 v[16:19], v89 offset:10240
    ds_read_b128 v[20:23], v89 offset:10752
    s_mov_b64 exec, -1
    ds_read_b128 v[12:15], v88 offset:11264
    v_exp_f32 v50, v50
    v_exp_f32 v51, v51
    v_exp_f32 v52, v52
    v_exp_f32 v53, v53
    s_waitcnt lgkmcnt(3)
    v_mfma_f32_32x32x16_bf16 v[32:47], v[8:11], v[4:7], 0
    s_setprio 1
    v_exp_f32 v54, v54
    v_exp_f32 v55, v55
    v_cvt_pk_bf16_f32 v64, v48, v49
    v_cvt_pk_bf16_f32 v65, v50, v51
    v_cvt_pk_bf16_f32 v66, v52, v53
    v_cvt_pk_bf16_f32 v67, v54, v55
    v_exp_f32 v56, v56
    v_exp_f32 v57, v57
    v_mfma_f32_32x32x16_bf16 v[72:87], v[24:27], v[64:67], v[72:87]
    s_setprio 0
    v_exp_f32 v58, v58
    v_exp_f32 v59, v59
    v_exp_f32 v60, v60
    v_exp_f32 v61, v61
    v_exp_f32 v62, v62
    v_exp_f32 v63, v63
    v_cvt_pk_bf16_f32 v68, v56, v57
    v_cvt_pk_bf16_f32 v69, v58, v59
    v_cvt_pk_bf16_f32 v70, v60, v61
    v_cvt_pk_bf16_f32 v71, v62, v63
    v_exp_f32 v32, v32
    v_exp_f32 v33, v33
    v_mfma_f32_32x32x16_bf16 v[72:87], v[28:31], v[68:71], v[72:87]
    s_mov_b64 exec, s[56:57]
    ds_read_b128 v[24:27], v89 offset:11264
    ds_read_b128 v[28:31], v89 offset:11776
    s_mov_b64 exec, -1
    ds_read_b128 v[8:11], v88 offset:12288
    v_exp_f32 v34, v34
    v_exp_f32 v35, v35
    v_exp_f32 v36, v36
    v_exp_f32 v37, v37
    s_waitcnt lgkmcnt(3)
    v_mfma_f32_32x32x16_bf16 v[48:63], v[12:15], v[4:7], 0
    s_setprio 1
    v_exp_f32 v38, v38
    v_exp_f32 v39, v39
    v_cvt_pk_bf16_f32 v64, v32, v33
    v_cvt_pk_bf16_f32 v65, v34, v35
    v_cvt_pk_bf16_f32 v66, v36, v37
    v_cvt_pk_bf16_f32 v67, v38, v39
    v_exp_f32 v40, v40
    v_exp_f32 v41, v41
    v_mfma_f32_32x32x16_bf16 v[72:87], v[16:19], v[64:67], v[72:87]
    s_setprio 0
    v_exp_f32 v42, v42
    v_exp_f32 v43, v43
    v_exp_f32 v44, v44
    v_exp_f32 v45, v45
    v_exp_f32 v46, v46
    v_exp_f32 v47, v47
    v_cvt_pk_bf16_f32 v68, v40, v41
    v_cvt_pk_bf16_f32 v69, v42, v43
    v_cvt_pk_bf16_f32 v70, v44, v45
    v_cvt_pk_bf16_f32 v71, v46, v47
    v_exp_f32 v48, v48
    v_exp_f32 v49, v49
    v_mfma_f32_32x32x16_bf16 v[72:87], v[20:23], v[68:71], v[72:87]
    s_mov_b64 exec, s[56:57]
    ds_read_b128 v[16:19], v89 offset:12288
    ds_read_b128 v[20:23], v89 offset:12800
    s_mov_b64 exec, -1
    ds_read_b128 v[12:15], v88 offset:13312
    v_exp_f32 v50, v50
    v_exp_f32 v51, v51
    v_exp_f32 v52, v52
    v_exp_f32 v53, v53
    s_waitcnt lgkmcnt(3)
    v_mfma_f32_32x32x16_bf16 v[32:47], v[8:11], v[4:7], 0
    s_setprio 1
    v_exp_f32 v54, v54
    v_exp_f32 v55, v55
    v_cvt_pk_bf16_f32 v64, v48, v49
    v_cvt_pk_bf16_f32 v65, v50, v51
    v_cvt_pk_bf16_f32 v66, v52, v53
    v_cvt_pk_bf16_f32 v67, v54, v55
    v_exp_f32 v56, v56
    v_exp_f32 v57, v57
    v_mfma_f32_32x32x16_bf16 v[72:87], v[24:27], v[64:67], v[72:87]
    s_setprio 0
    v_exp_f32 v58, v58
    v_exp_f32 v59, v59
    v_exp_f32 v60, v60
    v_exp_f32 v61, v61
    v_exp_f32 v62, v62
    v_exp_f32 v63, v63
    v_cvt_pk_bf16_f32 v68, v56, v57
    v_cvt_pk_bf16_f32 v69, v58, v59
    v_cvt_pk_bf16_f32 v70, v60, v61
    v_cvt_pk_bf16_f32 v71, v62, v63
    s_barrier
    v_exp_f32 v32, v32
    v_exp_f32 v33, v33
    v_mfma_f32_32x32x16_bf16 v[72:87], v[28:31], v[68:71], v[72:87]
    s_mov_b64 exec, s[56:57]
    ds_read_b128 v[24:27], v89 offset:13312
    ds_read_b128 v[28:31], v89 offset:13824
    s_mov_b64 exec, -1
    ds_read_b128 v[8:11], v88 offset:14336
    v_exp_f32 v34, v34
    v_exp_f32 v35, v35
    v_exp_f32 v36, v36
    v_exp_f32 v37, v37
    s_waitcnt lgkmcnt(3)
    v_mfma_f32_32x32x16_bf16 v[48:63], v[12:15], v[4:7], 0
    s_setprio 1
    v_exp_f32 v38, v38
    v_exp_f32 v39, v39
    v_cvt_pk_bf16_f32 v64, v32, v33
    v_cvt_pk_bf16_f32 v65, v34, v35
    v_cvt_pk_bf16_f32 v66, v36, v37
    v_cvt_pk_bf16_f32 v67, v38, v39
    v_exp_f32 v40, v40
    v_exp_f32 v41, v41
    v_mfma_f32_32x32x16_bf16 v[72:87], v[16:19], v[64:67], v[72:87]
    s_setprio 0
    v_exp_f32 v42, v42
    v_exp_f32 v43, v43
    v_exp_f32 v44, v44
    v_exp_f32 v45, v45
    v_exp_f32 v46, v46
    v_exp_f32 v47, v47
    v_cvt_pk_bf16_f32 v68, v40, v41
    v_cvt_pk_bf16_f32 v69, v42, v43
    v_cvt_pk_bf16_f32 v70, v44, v45
    v_cvt_pk_bf16_f32 v71, v46, v47
    v_exp_f32 v48, v48
    v_exp_f32 v49, v49
    v_mfma_f32_32x32x16_bf16 v[72:87], v[20:23], v[68:71], v[72:87]
    s_mov_b64 exec, s[56:57]
    ds_read_b128 v[16:19], v89 offset:14336
    ds_read_b128 v[20:23], v89 offset:14848
    s_mov_b64 exec, -1
    ds_read_b128 v[12:15], v88 offset:15360
    v_exp_f32 v50, v50
    v_exp_f32 v51, v51
    v_exp_f32 v52, v52
    v_exp_f32 v53, v53
    s_waitcnt lgkmcnt(3)
    v_mfma_f32_32x32x16_bf16 v[32:47], v[8:11], v[4:7], 0
    s_setprio 1
    v_exp_f32 v54, v54
    v_exp_f32 v55, v55
    v_cvt_pk_bf16_f32 v64, v48, v49
    v_cvt_pk_bf16_f32 v65, v50, v51
    v_cvt_pk_bf16_f32 v66, v52, v53
    v_cvt_pk_bf16_f32 v67, v54, v55
    v_exp_f32 v56, v56
    v_exp_f32 v57, v57
    v_mfma_f32_32x32x16_bf16 v[72:87], v[24:27], v[64:67], v[72:87]
    s_setprio 0
    v_exp_f32 v58, v58
    v_exp_f32 v59, v59
    v_exp_f32 v60, v60
    v_exp_f32 v61, v61
    v_exp_f32 v62, v62
    v_exp_f32 v63, v63
    v_cvt_pk_bf16_f32 v68, v56, v57
    v_cvt_pk_bf16_f32 v69, v58, v59
    v_cvt_pk_bf16_f32 v70, v60, v61
    v_cvt_pk_bf16_f32 v71, v62, v63
    v_exp_f32 v32, v32
    v_exp_f32 v33, v33
    v_mfma_f32_32x32x16_bf16 v[72:87], v[28:31], v[68:71], v[72:87]
    s_mov_b64 exec, s[56:57]
    ds_read_b128 v[24:27], v89 offset:15360
    ds_read_b128 v[28:31], v89 offset:15872
    s_mov_b64 exec, -1
    ds_read_b128 v[8:11], v88 offset:16384
    v_exp_f32 v34, v34
    v_exp_f32 v35, v35
    v_exp_f32 v36, v36
    v_exp_f32 v37, v37
    s_waitcnt lgkmcnt(3)
    v_mfma_f32_32x32x16_bf16 v[48:63], v[12:15], v[4:7], 0
    s_setprio 1
    v_exp_f32 v38, v38
    v_exp_f32 v39, v39
    v_cvt_pk_bf16_f32 v64, v32, v33
    v_cvt_pk_bf16_f32 v65, v34, v35
    v_cvt_pk_bf16_f32 v66, v36, v37
    v_cvt_pk_bf16_f32 v67, v38, v39
    v_exp_f32 v40, v40
    v_exp_f32 v41, v41
    v_mfma_f32_32x32x16_bf16 v[72:87], v[16:19], v[64:67], v[72:87]
    s_setprio 0
    v_exp_f32 v42, v42
    v_exp_f32 v43, v43
    v_exp_f32 v44, v44
    v_exp_f32 v45, v45
    v_exp_f32 v46, v46
    v_exp_f32 v47, v47
    v_cvt_pk_bf16_f32 v68, v40, v41
    v_cvt_pk_bf16_f32 v69, v42, v43
    v_cvt_pk_bf16_f32 v70, v44, v45
    v_cvt_pk_bf16_f32 v71, v46, v47
    s_waitcnt vmcnt(0)
    ds_read_b64_tr_b16 v[144:145], v93 offset:0
    ds_read_b64_tr_b16 v[146:147], v93 offset:1024
    ds_read_b64_tr_b16 v[148:149], v94 offset:0
    ds_read_b64_tr_b16 v[150:151], v94 offset:1024
    ds_read_b64_tr_b16 v[152:153], v93 offset:2048
    ds_read_b64_tr_b16 v[154:155], v93 offset:3072
    ds_read_b64_tr_b16 v[156:157], v94 offset:2048
    ds_read_b64_tr_b16 v[158:159], v94 offset:3072
    v_exp_f32 v48, v48
    v_exp_f32 v49, v49
    v_mfma_f32_32x32x16_bf16 v[72:87], v[20:23], v[68:71], v[72:87]
    s_mov_b64 exec, s[56:57]
    ds_read_b128 v[16:19], v89 offset:16384
    ds_read_b128 v[20:23], v89 offset:16896
    s_mov_b64 exec, -1
    ds_read_b128 v[12:15], v88 offset:17408
    v_exp_f32 v50, v50
    v_exp_f32 v51, v51
    v_exp_f32 v52, v52
    v_exp_f32 v53, v53
    s_waitcnt lgkmcnt(3)
    v_mfma_f32_32x32x16_bf16 v[32:47], v[8:11], v[4:7], 0
    s_setprio 1
    v_exp_f32 v54, v54
    v_exp_f32 v55, v55
    v_cvt_pk_bf16_f32 v64, v48, v49
    v_cvt_pk_bf16_f32 v65, v50, v51
    v_cvt_pk_bf16_f32 v66, v52, v53
    v_cvt_pk_bf16_f32 v67, v54, v55
    v_exp_f32 v56, v56
    v_exp_f32 v57, v57
    v_mfma_f32_32x32x16_bf16 v[72:87], v[24:27], v[64:67], v[72:87]
    s_setprio 0
    v_exp_f32 v58, v58
    v_exp_f32 v59, v59
    v_exp_f32 v60, v60
    v_exp_f32 v61, v61
    v_exp_f32 v62, v62
    v_exp_f32 v63, v63
    v_cvt_pk_bf16_f32 v68, v56, v57
    v_cvt_pk_bf16_f32 v69, v58, v59
    v_cvt_pk_bf16_f32 v70, v60, v61
    v_cvt_pk_bf16_f32 v71, v62, v63
    s_mov_b32 m0, s59
    s_mov_b32 s60, 229376
    buffer_load_dwordx4 v92, s[28:31], s60 offen lds
    buffer_load_dwordx4 v117, s[28:31], s60 offen offset:1024 lds
    buffer_load_dwordx4 v118, s[28:31], s60 offen offset:2048 lds
    buffer_load_dwordx4 v119, s[28:31], s60 offen offset:3072 lds
    v_exp_f32 v32, v32
    v_exp_f32 v33, v33
    v_mfma_f32_32x32x16_bf16 v[72:87], v[28:31], v[68:71], v[72:87]
    s_mov_b64 exec, s[56:57]
    ds_read_b128 v[24:27], v89 offset:17408
    ds_read_b128 v[28:31], v89 offset:17920
    s_mov_b64 exec, -1
    ds_read_b128 v[8:11], v88 offset:18432
    v_exp_f32 v34, v34
    v_exp_f32 v35, v35
    v_exp_f32 v36, v36
    v_exp_f32 v37, v37
    s_waitcnt lgkmcnt(3)
    v_mfma_f32_32x32x16_bf16 v[48:63], v[12:15], v[4:7], 0
    s_setprio 1
    v_exp_f32 v38, v38
    v_exp_f32 v39, v39
    v_cvt_pk_bf16_f32 v64, v32, v33
    v_cvt_pk_bf16_f32 v65, v34, v35
    v_cvt_pk_bf16_f32 v66, v36, v37
    v_cvt_pk_bf16_f32 v67, v38, v39
    v_exp_f32 v40, v40
    v_exp_f32 v41, v41
    v_mfma_f32_32x32x16_bf16 v[72:87], v[16:19], v[64:67], v[72:87]
    s_setprio 0
    v_exp_f32 v42, v42
    v_exp_f32 v43, v43
    v_exp_f32 v44, v44
    v_exp_f32 v45, v45
    v_exp_f32 v46, v46
    v_exp_f32 v47, v47
    v_cvt_pk_bf16_f32 v68, v40, v41
    v_cvt_pk_bf16_f32 v69, v42, v43
    v_cvt_pk_bf16_f32 v70, v44, v45
    v_cvt_pk_bf16_f32 v71, v46, v47
    v_exp_f32 v48, v48
    v_exp_f32 v49, v49
    v_mfma_f32_32x32x16_bf16 v[72:87], v[20:23], v[68:71], v[72:87]
    s_mov_b64 exec, s[56:57]
    ds_read_b128 v[16:19], v89 offset:18432
    ds_read_b128 v[20:23], v89 offset:18944
    s_mov_b64 exec, -1
    ds_read_b128 v[12:15], v88 offset:19456
    v_exp_f32 v50, v50
    v_exp_f32 v51, v51
    v_exp_f32 v52, v52
    v_exp_f32 v53, v53
    s_waitcnt lgkmcnt(3)
    v_mfma_f32_32x32x16_bf16 v[32:47], v[8:11], v[4:7], 0
    s_setprio 1
    v_exp_f32 v54, v54
    v_exp_f32 v55, v55
    v_cvt_pk_bf16_f32 v64, v48, v49
    v_cvt_pk_bf16_f32 v65, v50, v51
    v_cvt_pk_bf16_f32 v66, v52, v53
    v_cvt_pk_bf16_f32 v67, v54, v55
    v_exp_f32 v56, v56
    v_exp_f32 v57, v57
    v_mfma_f32_32x32x16_bf16 v[72:87], v[24:27], v[64:67], v[72:87]
    s_setprio 0
    v_exp_f32 v58, v58
    v_exp_f32 v59, v59
    v_exp_f32 v60, v60
    v_exp_f32 v61, v61
    v_exp_f32 v62, v62
    v_exp_f32 v63, v63
    v_cvt_pk_bf16_f32 v68, v56, v57
    v_cvt_pk_bf16_f32 v69, v58, v59
    v_cvt_pk_bf16_f32 v70, v60, v61
    v_cvt_pk_bf16_f32 v71, v62, v63
    v_exp_f32 v32, v32
    v_exp_f32 v33, v33
    v_mfma_f32_32x32x16_bf16 v[72:87], v[28:31], v[68:71], v[72:87]
    s_mov_b64 exec, s[56:57]
    ds_read_b128 v[24:27], v89 offset:19456
    ds_read_b128 v[28:31], v89 offset:19968
    s_mov_b64 exec, -1
    ds_read_b128 v[8:11], v88 offset:20480
    v_exp_f32 v34, v34
    v_exp_f32 v35, v35
    v_exp_f32 v36, v36
    v_exp_f32 v37, v37
    s_waitcnt lgkmcnt(3)
    v_mfma_f32_32x32x16_bf16 v[48:63], v[12:15], v[4:7], 0
    s_setprio 1
    v_exp_f32 v38, v38
    v_exp_f32 v39, v39
    v_cvt_pk_bf16_f32 v64, v32, v33
    v_cvt_pk_bf16_f32 v65, v34, v35
    v_cvt_pk_bf16_f32 v66, v36, v37
    v_cvt_pk_bf16_f32 v67, v38, v39
    v_exp_f32 v40, v40
    v_exp_f32 v41, v41
    v_mfma_f32_32x32x16_bf16 v[72:87], v[16:19], v[64:67], v[72:87]
    s_setprio 0
    v_exp_f32 v42, v42
    v_exp_f32 v43, v43
    v_exp_f32 v44, v44
    v_exp_f32 v45, v45
    v_exp_f32 v46, v46
    v_exp_f32 v47, v47
    v_cvt_pk_bf16_f32 v68, v40, v41
    v_cvt_pk_bf16_f32 v69, v42, v43
    v_cvt_pk_bf16_f32 v70, v44, v45
    v_cvt_pk_bf16_f32 v71, v46, v47
    v_exp_f32 v48, v48
    v_exp_f32 v49, v49
    v_mfma_f32_32x32x16_bf16 v[72:87], v[20:23], v[68:71], v[72:87]
    s_mov_b64 exec, s[56:57]
    ds_read_b128 v[16:19], v89 offset:20480
    ds_read_b128 v[20:23], v89 offset:20992
    s_mov_b64 exec, -1
    ds_read_b128 v[12:15], v88 offset:21504
    v_exp_f32 v50, v50
    v_exp_f32 v51, v51
    v_exp_f32 v52, v52
    v_exp_f32 v53, v53
    s_waitcnt lgkmcnt(3)
    v_mfma_f32_32x32x16_bf16 v[32:47], v[8:11], v[4:7], 0
    s_setprio 1
    v_exp_f32 v54, v54
    v_exp_f32 v55, v55
    v_cvt_pk_bf16_f32 v64, v48, v49
    v_cvt_pk_bf16_f32 v65, v50, v51
    v_cvt_pk_bf16_f32 v66, v52, v53
    v_cvt_pk_bf16_f32 v67, v54, v55
    v_exp_f32 v56, v56
    v_exp_f32 v57, v57
    v_mfma_f32_32x32x16_bf16 v[72:87], v[24:27], v[64:67], v[72:87]
    s_setprio 0
    v_exp_f32 v58, v58
    v_exp_f32 v59, v59
    v_exp_f32 v60, v60
    v_exp_f32 v61, v61
    v_exp_f32 v62, v62
    v_exp_f32 v63, v63
    v_cvt_pk_bf16_f32 v68, v56, v57
    v_cvt_pk_bf16_f32 v69, v58, v59
    v_cvt_pk_bf16_f32 v70, v60, v61
    v_cvt_pk_bf16_f32 v71, v62, v63
    v_exp_f32 v32, v32
    v_exp_f32 v33, v33
    v_mfma_f32_32x32x16_bf16 v[72:87], v[28:31], v[68:71], v[72:87]
    s_mov_b64 exec, s[56:57]
    ds_read_b128 v[24:27], v89 offset:21504
    ds_read_b128 v[28:31], v89 offset:22016
    s_mov_b64 exec, -1
    ds_read_b128 v[8:11], v88 offset:22528
    v_exp_f32 v34, v34
    v_exp_f32 v35, v35
    v_exp_f32 v36, v36
    v_exp_f32 v37, v37
    s_waitcnt lgkmcnt(3)
    v_mfma_f32_32x32x16_bf16 v[48:63], v[12:15], v[4:7], 0
    s_setprio 1
    v_exp_f32 v38, v38
    v_exp_f32 v39, v39
    v_cvt_pk_bf16_f32 v64, v32, v33
    v_cvt_pk_bf16_f32 v65, v34, v35
    v_cvt_pk_bf16_f32 v66, v36, v37
    v_cvt_pk_bf16_f32 v67, v38, v39
    v_exp_f32 v40, v40
    v_exp_f32 v41, v41
    v_mfma_f32_32x32x16_bf16 v[72:87], v[16:19], v[64:67], v[72:87]
    s_setprio 0
    v_exp_f32 v42, v42
    v_exp_f32 v43, v43
    v_exp_f32 v44, v44
    v_exp_f32 v45, v45
    v_exp_f32 v46, v46
    v_exp_f32 v47, v47
    v_cvt_pk_bf16_f32 v68, v40, v41
    v_cvt_pk_bf16_f32 v69, v42, v43
    v_cvt_pk_bf16_f32 v70, v44, v45
    v_cvt_pk_bf16_f32 v71, v46, v47
    v_exp_f32 v48, v48
    v_exp_f32 v49, v49
    v_mfma_f32_32x32x16_bf16 v[72:87], v[20:23], v[68:71], v[72:87]
    s_mov_b64 exec, s[56:57]
    ds_read_b128 v[16:19], v89 offset:22528
    ds_read_b128 v[20:23], v89 offset:23040
    s_mov_b64 exec, -1
    ds_read_b128 v[12:15], v88 offset:23552
    v_exp_f32 v50, v50
    v_exp_f32 v51, v51
    v_exp_f32 v52, v52
    v_exp_f32 v53, v53
    s_waitcnt lgkmcnt(3)
    v_mfma_f32_32x32x16_bf16 v[32:47], v[8:11], v[4:7], 0
    s_setprio 1
    v_exp_f32 v54, v54
    v_exp_f32 v55, v55
    v_cvt_pk_bf16_f32 v64, v48, v49
    v_cvt_pk_bf16_f32 v65, v50, v51
    v_cvt_pk_bf16_f32 v66, v52, v53
    v_cvt_pk_bf16_f32 v67, v54, v55
    v_exp_f32 v56, v56
    v_exp_f32 v57, v57
    v_mfma_f32_32x32x16_bf16 v[72:87], v[24:27], v[64:67], v[72:87]
    s_setprio 0
    v_exp_f32 v58, v58
    v_exp_f32 v59, v59
    v_exp_f32 v60, v60
    v_exp_f32 v61, v61
    v_exp_f32 v62, v62
    v_exp_f32 v63, v63
    v_cvt_pk_bf16_f32 v68, v56, v57
    v_cvt_pk_bf16_f32 v69, v58, v59
    v_cvt_pk_bf16_f32 v70, v60, v61
    v_cvt_pk_bf16_f32 v71, v62, v63
    v_exp_f32 v32, v32
    v_exp_f32 v33, v33
    v_mfma_f32_32x32x16_bf16 v[72:87], v[28:31], v[68:71], v[72:87]
    s_mov_b64 exec, s[56:57]
    ds_read_b128 v[24:27], v89 offset:23552
    ds_read_b128 v[28:31], v89 offset:24064
    s_mov_b64 exec, -1
    ds_read_b128 v[8:11], v88 offset:24576
    v_exp_f32 v34, v34
    v_exp_f32 v35, v35
    v_exp_f32 v36, v36
    v_exp_f32 v37, v37
    s_waitcnt lgkmcnt(3)
    v_mfma_f32_32x32x16_bf16 v[48:63], v[12:15], v[4:7], 0
    s_setprio 1
    v_exp_f32 v38, v38
    v_exp_f32 v39, v39
    v_cvt_pk_bf16_f32 v64, v32, v33
    v_cvt_pk_bf16_f32 v65, v34, v35
    v_cvt_pk_bf16_f32 v66, v36, v37
    v_cvt_pk_bf16_f32 v67, v38, v39
    v_exp_f32 v40, v40
    v_exp_f32 v41, v41
    v_mfma_f32_32x32x16_bf16 v[72:87], v[16:19], v[64:67], v[72:87]
    s_setprio 0
    v_exp_f32 v42, v42
    v_exp_f32 v43, v43
    v_exp_f32 v44, v44
    v_exp_f32 v45, v45
    v_exp_f32 v46, v46
    v_exp_f32 v47, v47
    v_cvt_pk_bf16_f32 v68, v40, v41
    v_cvt_pk_bf16_f32 v69, v42, v43
    v_cvt_pk_bf16_f32 v70, v44, v45
    v_cvt_pk_bf16_f32 v71, v46, v47
    s_waitcnt vmcnt(0)
    ds_read_b64_tr_b16 v[160:161], v93 offset:0
    ds_read_b64_tr_b16 v[162:163], v93 offset:1024
    ds_read_b64_tr_b16 v[164:165], v94 offset:0
    ds_read_b64_tr_b16 v[166:167], v94 offset:1024
    ds_read_b64_tr_b16 v[168:169], v93 offset:2048
    ds_read_b64_tr_b16 v[170:171], v93 offset:3072
    ds_read_b64_tr_b16 v[172:173], v94 offset:2048
    ds_read_b64_tr_b16 v[174:175], v94 offset:3072
    v_exp_f32 v48, v48
    v_exp_f32 v49, v49
    v_mfma_f32_32x32x16_bf16 v[72:87], v[20:23], v[68:71], v[72:87]
    s_mov_b64 exec, s[56:57]
    ds_read_b128 v[16:19], v89 offset:24576
    ds_read_b128 v[20:23], v89 offset:25088
    s_mov_b64 exec, -1
    ds_read_b128 v[12:15], v88 offset:25600
    v_exp_f32 v50, v50
    v_exp_f32 v51, v51
    v_exp_f32 v52, v52
    v_exp_f32 v53, v53
    s_waitcnt lgkmcnt(3)
    v_mfma_f32_32x32x16_bf16 v[32:47], v[8:11], v[4:7], 0
    s_setprio 1
    v_exp_f32 v54, v54
    v_exp_f32 v55, v55
    v_cvt_pk_bf16_f32 v64, v48, v49
    v_cvt_pk_bf16_f32 v65, v50, v51
    v_cvt_pk_bf16_f32 v66, v52, v53
    v_cvt_pk_bf16_f32 v67, v54, v55
    v_exp_f32 v56, v56
    v_exp_f32 v57, v57
    v_mfma_f32_32x32x16_bf16 v[72:87], v[24:27], v[64:67], v[72:87]
    s_setprio 0
    v_exp_f32 v58, v58
    v_exp_f32 v59, v59
    v_exp_f32 v60, v60
    v_exp_f32 v61, v61
    v_exp_f32 v62, v62
    v_exp_f32 v63, v63
    v_cvt_pk_bf16_f32 v68, v56, v57
    v_cvt_pk_bf16_f32 v69, v58, v59
    v_cvt_pk_bf16_f32 v70, v60, v61
    v_cvt_pk_bf16_f32 v71, v62, v63
    s_mov_b32 m0, s59
    s_mov_b32 s60, 344064
    buffer_load_dwordx4 v92, s[28:31], s60 offen lds
    buffer_load_dwordx4 v117, s[28:31], s60 offen offset:1024 lds
    buffer_load_dwordx4 v118, s[28:31], s60 offen offset:2048 lds
    buffer_load_dwordx4 v119, s[28:31], s60 offen offset:3072 lds
    v_exp_f32 v32, v32
    v_exp_f32 v33, v33
    v_mfma_f32_32x32x16_bf16 v[72:87], v[28:31], v[68:71], v[72:87]
    s_mov_b64 exec, s[56:57]
    ds_read_b128 v[24:27], v89 offset:25600
    ds_read_b128 v[28:31], v89 offset:26112
    s_mov_b64 exec, -1
    ds_read_b128 v[8:11], v88 offset:26624
    v_exp_f32 v34, v34
    v_exp_f32 v35, v35
    v_exp_f32 v36, v36
    v_exp_f32 v37, v37
    s_waitcnt lgkmcnt(3)
    v_mfma_f32_32x32x16_bf16 v[48:63], v[12:15], v[4:7], 0
    s_setprio 1
    v_exp_f32 v38, v38
    v_exp_f32 v39, v39
    v_cvt_pk_bf16_f32 v64, v32, v33
    v_cvt_pk_bf16_f32 v65, v34, v35
    v_cvt_pk_bf16_f32 v66, v36, v37
    v_cvt_pk_bf16_f32 v67, v38, v39
    v_exp_f32 v40, v40
    v_exp_f32 v41, v41
    v_mfma_f32_32x32x16_bf16 v[72:87], v[16:19], v[64:67], v[72:87]
    s_setprio 0
    v_exp_f32 v42, v42
    v_exp_f32 v43, v43
    v_exp_f32 v44, v44
    v_exp_f32 v45, v45
    v_exp_f32 v46, v46
    v_exp_f32 v47, v47
    v_cvt_pk_bf16_f32 v68, v40, v41
    v_cvt_pk_bf16_f32 v69, v42, v43
    v_cvt_pk_bf16_f32 v70, v44, v45
    v_cvt_pk_bf16_f32 v71, v46, v47
    v_exp_f32 v48, v48
    v_exp_f32 v49, v49
    v_mfma_f32_32x32x16_bf16 v[72:87], v[20:23], v[68:71], v[72:87]
    s_mov_b64 exec, s[56:57]
    ds_read_b128 v[16:19], v89 offset:26624
    ds_read_b128 v[20:23], v89 offset:27136
    s_mov_b64 exec, -1
    ds_read_b128 v[12:15], v88 offset:27648
    v_exp_f32 v50, v50
    v_exp_f32 v51, v51
    v_exp_f32 v52, v52
    v_exp_f32 v53, v53
    s_waitcnt lgkmcnt(3)
    v_mfma_f32_32x32x16_bf16 v[32:47], v[8:11], v[4:7], 0
    s_setprio 1
    v_exp_f32 v54, v54
    v_exp_f32 v55, v55
    v_cvt_pk_bf16_f32 v64, v48, v49
    v_cvt_pk_bf16_f32 v65, v50, v51
    v_cvt_pk_bf16_f32 v66, v52, v53
    v_cvt_pk_bf16_f32 v67, v54, v55
    v_exp_f32 v56, v56
    v_exp_f32 v57, v57
    v_mfma_f32_32x32x16_bf16 v[72:87], v[24:27], v[64:67], v[72:87]
    s_setprio 0
    v_exp_f32 v58, v58
    v_exp_f32 v59, v59
    v_exp_f32 v60, v60
    v_exp_f32 v61, v61
    v_exp_f32 v62, v62
    v_exp_f32 v63, v63
    v_cvt_pk_bf16_f32 v68, v56, v57
    v_cvt_pk_bf16_f32 v69, v58, v59
    v_cvt_pk_bf16_f32 v70, v60, v61
    v_cvt_pk_bf16_f32 v71, v62, v63
    v_exp_f32 v32, v32
    v_exp_f32 v33, v33
    v_mfma_f32_32x32x16_bf16 v[72:87], v[28:31], v[68:71], v[72:87]
    s_mov_b64 exec, s[56:57]
    ds_read_b128 v[24:27], v89 offset:27648
    ds_read_b128 v[28:31], v89 offset:28160
    s_mov_b64 exec, -1
    ds_read_b128 v[8:11], v88 offset:28672
    v_exp_f32 v34, v34
    v_exp_f32 v35, v35
    v_exp_f32 v36, v36
    v_exp_f32 v37, v37
    s_waitcnt lgkmcnt(3)
    v_mfma_f32_32x32x16_bf16 v[48:63], v[12:15], v[4:7], 0
    s_setprio 1
    v_exp_f32 v38, v38
    v_exp_f32 v39, v39
    v_cvt_pk_bf16_f32 v64, v32, v33
    v_cvt_pk_bf16_f32 v65, v34, v35
    v_cvt_pk_bf16_f32 v66, v36, v37
    v_cvt_pk_bf16_f32 v67, v38, v39
    v_exp_f32 v40, v40
    v_exp_f32 v41, v41
    v_mfma_f32_32x32x16_bf16 v[72:87], v[16:19], v[64:67], v[72:87]
    s_setprio 0
    v_exp_f32 v42, v42
    v_exp_f32 v43, v43
    v_exp_f32 v44, v44
    v_exp_f32 v45, v45
    v_exp_f32 v46, v46
    v_exp_f32 v47, v47
    v_cvt_pk_bf16_f32 v68, v40, v41
    v_cvt_pk_bf16_f32 v69, v42, v43
    v_cvt_pk_bf16_f32 v70, v44, v45
    v_cvt_pk_bf16_f32 v71, v46, v47
    buffer_load_dword v97, v96, s[32:35], 0 offen
    v_exp_f32 v48, v48
    v_exp_f32 v49, v49
    v_mfma_f32_32x32x16_bf16 v[72:87], v[20:23], v[68:71], v[72:87]
    s_mov_b64 exec, s[56:57]
    ds_read_b128 v[16:19], v89 offset:28672
    ds_read_b128 v[20:23], v89 offset:29184
    s_mov_b64 exec, -1
    ds_read_b128 v[12:15], v88 offset:29696
    v_exp_f32 v50, v50
    v_exp_f32 v51, v51
    v_exp_f32 v52, v52
    v_exp_f32 v53, v53
    s_waitcnt lgkmcnt(3)
    v_mfma_f32_32x32x16_bf16 v[32:47], v[8:11], v[4:7], 0
    s_setprio 1
    v_exp_f32 v54, v54
    v_exp_f32 v55, v55
    v_cvt_pk_bf16_f32 v64, v48, v49
    v_cvt_pk_bf16_f32 v65, v50, v51
    v_cvt_pk_bf16_f32 v66, v52, v53
    v_cvt_pk_bf16_f32 v67, v54, v55
    v_exp_f32 v56, v56
    v_exp_f32 v57, v57
    v_mfma_f32_32x32x16_bf16 v[72:87], v[24:27], v[64:67], v[72:87]
    s_setprio 0
    v_exp_f32 v58, v58
    v_exp_f32 v59, v59
    v_exp_f32 v60, v60
    v_exp_f32 v61, v61
    v_exp_f32 v62, v62
    v_exp_f32 v63, v63
    v_cvt_pk_bf16_f32 v68, v56, v57
    v_cvt_pk_bf16_f32 v69, v58, v59
    v_cvt_pk_bf16_f32 v70, v60, v61
    v_cvt_pk_bf16_f32 v71, v62, v63
    s_barrier
    s_cmp_lg_u32 s3, 0
    s_cbranch_scc1 L_ma_12
    s_and_b32 s60, s2, 7
    s_lshl_b32 s60, s60, 8
    s_add_u32 s60, s60, 14944256
    v_mov_b32 v114, 1
    v_mov_b32 v115, 0
    v_cmp_eq_u32 vcc, 0, v0
    s_and_saveexec_b64 s[62:63], vcc
    buffer_atomic_add v114, v115, s[68:71], s60 offen
    s_mov_b64 exec, s[62:63]
L_ma_12:
    v_exp_f32 v32, v32
    v_exp_f32 v33, v33
    v_mfma_f32_32x32x16_bf16 v[72:87], v[28:31], v[68:71], v[72:87]
    s_mov_b64 exec, s[56:57]
    ds_read_b128 v[24:27], v89 offset:29696
    ds_read_b128 v[28:31], v89 offset:30208
    s_mov_b64 exec, -1
    ds_read_b128 v[8:11], v88 offset:30720
    v_exp_f32 v34, v34
    v_exp_f32 v35, v35
    v_exp_f32 v36, v36
    v_exp_f32 v37, v37
    s_waitcnt lgkmcnt(3)
    v_mfma_f32_32x32x16_bf16 v[48:63], v[12:15], v[4:7], 0
    s_setprio 1
    v_exp_f32 v38, v38
    v_exp_f32 v39, v39
    v_cvt_pk_bf16_f32 v64, v32, v33
    v_cvt_pk_bf16_f32 v65, v34, v35
    v_cvt_pk_bf16_f32 v66, v36, v37
    v_cvt_pk_bf16_f32 v67, v38, v39
    v_exp_f32 v40, v40
    v_exp_f32 v41, v41
    v_mfma_f32_32x32x16_bf16 v[72:87], v[16:19], v[64:67], v[72:87]
    s_setprio 0
    v_exp_f32 v42, v42
    v_exp_f32 v43, v43
    v_exp_f32 v44, v44
    v_exp_f32 v45, v45
    v_exp_f32 v46, v46
    v_exp_f32 v47, v47
    v_cvt_pk_bf16_f32 v68, v40, v41
    v_cvt_pk_bf16_f32 v69, v42, v43
    v_cvt_pk_bf16_f32 v70, v44, v45
    v_cvt_pk_bf16_f32 v71, v46, v47
    v_exp_f32 v48, v48
    v_exp_f32 v49, v49
    v_mfma_f32_32x32x16_bf16 v[72:87], v[20:23], v[68:71], v[72:87]
    s_mov_b64 exec, s[56:57]
    ds_read_b128 v[16:19], v89 offset:30720
    ds_read_b128 v[20:23], v89 offset:31232
    s_mov_b64 exec, -1
    ds_read_b128 v[12:15], v88 offset:31744
    v_exp_f32 v50, v50
    v_exp_f32 v51, v51
    v_exp_f32 v52, v52
    v_exp_f32 v53, v53
    s_waitcnt lgkmcnt(3)
    v_mfma_f32_32x32x16_bf16 v[32:47], v[8:11], v[4:7], 0
    s_setprio 1
    v_exp_f32 v54, v54
    v_exp_f32 v55, v55
    v_cvt_pk_bf16_f32 v64, v48, v49
    v_cvt_pk_bf16_f32 v65, v50, v51
    v_cvt_pk_bf16_f32 v66, v52, v53
    v_cvt_pk_bf16_f32 v67, v54, v55
    v_exp_f32 v56, v56
    v_exp_f32 v57, v57
    v_mfma_f32_32x32x16_bf16 v[72:87], v[24:27], v[64:67], v[72:87]
    s_setprio 0
    v_exp_f32 v58, v58
    v_exp_f32 v59, v59
    v_exp_f32 v60, v60
    v_exp_f32 v61, v61
    v_exp_f32 v62, v62
    v_exp_f32 v63, v63
    v_cvt_pk_bf16_f32 v68, v56, v57
    v_cvt_pk_bf16_f32 v69, v58, v59
    v_cvt_pk_bf16_f32 v70, v60, v61
    v_cvt_pk_bf16_f32 v71, v62, v63
    v_exp_f32 v32, v32
    v_exp_f32 v33, v33
    v_mfma_f32_32x32x16_bf16 v[72:87], v[28:31], v[68:71], v[72:87]
    s_mov_b64 exec, s[56:57]
    ds_read_b128 v[24:27], v89 offset:31744
    ds_read_b128 v[28:31], v89 offset:32256
    s_mov_b64 exec, -1
    ds_read_b128 v[8:11], v88 offset:32768
    v_exp_f32 v34, v34
    v_exp_f32 v35, v35
    v_exp_f32 v36, v36
    v_exp_f32 v37, v37
    s_waitcnt lgkmcnt(3)
    v_mfma_f32_32x32x16_bf16 v[48:63], v[12:15], v[4:7], 0
    s_setprio 1
    v_exp_f32 v38, v38
    v_exp_f32 v39, v39
    v_cvt_pk_bf16_f32 v64, v32, v33
    v_cvt_pk_bf16_f32 v65, v34, v35
    v_cvt_pk_bf16_f32 v66, v36, v37
    v_cvt_pk_bf16_f32 v67, v38, v39
    v_exp_f32 v40, v40
    v_exp_f32 v41, v41
    v_mfma_f32_32x32x16_bf16 v[72:87], v[16:19], v[64:67], v[72:87]
    s_setprio 0
    v_exp_f32 v42, v42
    v_exp_f32 v43, v43
    v_exp_f32 v44, v44
    v_exp_f32 v45, v45
    v_exp_f32 v46, v46
    v_exp_f32 v47, v47
    v_cvt_pk_bf16_f32 v68, v40, v41
    v_cvt_pk_bf16_f32 v69, v42, v43
    v_cvt_pk_bf16_f32 v70, v44, v45
    v_cvt_pk_bf16_f32 v71, v46, v47
    s_waitcnt vmcnt(1)
    ds_read_b64_tr_b16 v[176:177], v93 offset:0
    ds_read_b64_tr_b16 v[178:179], v93 offset:1024
    ds_read_b64_tr_b16 v[180:181], v94 offset:0
    ds_read_b64_tr_b16 v[182:183], v94 offset:1024
    ds_read_b64_tr_b16 v[184:185], v93 offset:2048
    ds_read_b64_tr_b16 v[186:187], v93 offset:3072
    ds_read_b64_tr_b16 v[188:189], v94 offset:2048
    ds_read_b64_tr_b16 v[190:191], v94 offset:3072
    v_exp_f32 v48, v48
    v_exp_f32 v49, v49
    v_mfma_f32_32x32x16_bf16 v[72:87], v[20:23], v[68:71], v[72:87]
    s_mov_b64 exec, s[56:57]
    ds_read_b128 v[16:19], v89 offset:32768
    ds_read_b128 v[20:23], v89 offset:33280
    s_mov_b64 exec, -1
    ds_read_b128 v[12:15], v88 offset:33792
    v_exp_f32 v50, v50
    v_exp_f32 v51, v51
    v_exp_f32 v52, v52
    v_exp_f32 v53, v53
    s_waitcnt lgkmcnt(3)
    v_mfma_f32_32x32x16_bf16 v[32:47], v[8:11], v[4:7], 0
    s_setprio 1
    v_exp_f32 v54, v54
    v_exp_f32 v55, v55
    v_cvt_pk_bf16_f32 v64, v48, v49
    v_cvt_pk_bf16_f32 v65, v50, v51
    v_cvt_pk_bf16_f32 v66, v52, v53
    v_cvt_pk_bf16_f32 v67, v54, v55
    v_exp_f32 v56, v56
    v_exp_f32 v57, v57
    v_mfma_f32_32x32x16_bf16 v[72:87], v[24:27], v[64:67], v[72:87]
    s_setprio 0
    v_exp_f32 v58, v58
    v_exp_f32 v59, v59
    v_exp_f32 v60, v60
    v_exp_f32 v61, v61
    v_exp_f32 v62, v62
    v_exp_f32 v63, v63
    v_cvt_pk_bf16_f32 v68, v56, v57
    v_cvt_pk_bf16_f32 v69, v58, v59
    v_cvt_pk_bf16_f32 v70, v60, v61
    v_cvt_pk_bf16_f32 v71, v62, v63
    s_mov_b32 m0, s59
    s_mov_b32 s60, 458752
    buffer_load_dwordx4 v92, s[28:31], s60 offen lds
    buffer_load_dwordx4 v117, s[28:31], s60 offen offset:1024 lds
    buffer_load_dwordx4 v118, s[28:31], s60 offen offset:2048 lds
    buffer_load_dwordx4 v119, s[28:31], s60 offen offset:3072 lds
    v_exp_f32 v32, v32
    v_exp_f32 v33, v33
    v_mfma_f32_32x32x16_bf16 v[72:87], v[28:31], v[68:71], v[72:87]
    s_mov_b64 exec, s[56:57]
    ds_read_b128 v[24:27], v89 offset:33792
    ds_read_b128 v[28:31], v89 offset:34304
    s_mov_b64 exec, -1
    ds_read_b128 v[8:11], v88 offset:34816
    v_exp_f32 v34, v34
    v_exp_f32 v35, v35
    v_exp_f32 v36, v36
    v_exp_f32 v37, v37
    s_waitcnt lgkmcnt(3)
    v_mfma_f32_32x32x16_bf16 v[48:63], v[12:15], v[4:7], 0
    s_setprio 1
    v_exp_f32 v38, v38
    v_exp_f32 v39, v39
    v_cvt_pk_bf16_f32 v64, v32, v33
    v_cvt_pk_bf16_f32 v65, v34, v35
    v_cvt_pk_bf16_f32 v66, v36, v37
    v_cvt_pk_bf16_f32 v67, v38, v39
    v_exp_f32 v40, v40
    v_exp_f32 v41, v41
    v_mfma_f32_32x32x16_bf16 v[72:87], v[16:19], v[64:67], v[72:87]
    s_setprio 0
    v_exp_f32 v42, v42
    v_exp_f32 v43, v43
    v_exp_f32 v44, v44
    v_exp_f32 v45, v45
    v_exp_f32 v46, v46
    v_exp_f32 v47, v47
    v_cvt_pk_bf16_f32 v68, v40, v41
    v_cvt_pk_bf16_f32 v69, v42, v43
    v_cvt_pk_bf16_f32 v70, v44, v45
    v_cvt_pk_bf16_f32 v71, v46, v47
    v_exp_f32 v48, v48
    v_exp_f32 v49, v49
    v_mfma_f32_32x32x16_bf16 v[72:87], v[20:23], v[68:71], v[72:87]
    s_mov_b64 exec, s[56:57]
    ds_read_b128 v[16:19], v89 offset:34816
    ds_read_b128 v[20:23], v89 offset:35328
    s_mov_b64 exec, -1
    ds_read_b128 v[12:15], v88 offset:35840
    v_exp_f32 v50, v50
    v_exp_f32 v51, v51
    v_exp_f32 v52, v52
    v_exp_f32 v53, v53
    s_waitcnt lgkmcnt(3)
    v_mfma_f32_32x32x16_bf16 v[32:47], v[8:11], v[4:7], 0
    s_setprio 1
    v_exp_f32 v54, v54
    v_exp_f32 v55, v55
    v_cvt_pk_bf16_f32 v64, v48, v49
    v_cvt_pk_bf16_f32 v65, v50, v51
    v_cvt_pk_bf16_f32 v66, v52, v53
    v_cvt_pk_bf16_f32 v67, v54, v55
    v_exp_f32 v56, v56
    v_exp_f32 v57, v57
    v_mfma_f32_32x32x16_bf16 v[72:87], v[24:27], v[64:67], v[72:87]
    s_setprio 0
    v_exp_f32 v58, v58
    v_exp_f32 v59, v59
    v_exp_f32 v60, v60
    v_exp_f32 v61, v61
    v_exp_f32 v62, v62
    v_exp_f32 v63, v63
    v_cvt_pk_bf16_f32 v68, v56, v57
    v_cvt_pk_bf16_f32 v69, v58, v59
    v_cvt_pk_bf16_f32 v70, v60, v61
    v_cvt_pk_bf16_f32 v71, v62, v63
    v_exp_f32 v32, v32
    v_exp_f32 v33, v33
    v_mfma_f32_32x32x16_bf16 v[72:87], v[28:31], v[68:71], v[72:87]
    s_mov_b64 exec, s[56:57]
    ds_read_b128 v[24:27], v89 offset:35840
    ds_read_b128 v[28:31], v89 offset:36352
    s_mov_b64 exec, -1
    ds_read_b128 v[8:11], v88 offset:36864
    v_exp_f32 v34, v34
    v_exp_f32 v35, v35
    v_exp_f32 v36, v36
    v_exp_f32 v37, v37
    s_waitcnt lgkmcnt(3)
    v_mfma_f32_32x32x16_bf16 v[48:63], v[12:15], v[4:7], 0
    s_setprio 1
    v_exp_f32 v38, v38
    v_exp_f32 v39, v39
    v_cvt_pk_bf16_f32 v64, v32, v33
    v_cvt_pk_bf16_f32 v65, v34, v35
    v_cvt_pk_bf16_f32 v66, v36, v37
    v_cvt_pk_bf16_f32 v67, v38, v39
    v_exp_f32 v40, v40
    v_exp_f32 v41, v41
    v_mfma_f32_32x32x16_bf16 v[72:87], v[16:19], v[64:67], v[72:87]
    s_setprio 0
    v_exp_f32 v42, v42
    v_exp_f32 v43, v43
    v_exp_f32 v44, v44
    v_exp_f32 v45, v45
    v_exp_f32 v46, v46
    v_exp_f32 v47, v47
    v_cvt_pk_bf16_f32 v68, v40, v41
    v_cvt_pk_bf16_f32 v69, v42, v43
    v_cvt_pk_bf16_f32 v70, v44, v45
    v_cvt_pk_bf16_f32 v71, v46, v47
    v_exp_f32 v48, v48
    v_exp_f32 v49, v49
    v_mfma_f32_32x32x16_bf16 v[72:87], v[20:23], v[68:71], v[72:87]
    s_mov_b64 exec, s[56:57]
    ds_read_b128 v[16:19], v89 offset:36864
    ds_read_b128 v[20:23], v89 offset:37376
    s_mov_b64 exec, -1
    ds_read_b128 v[12:15], v88 offset:37888
    v_exp_f32 v50, v50
    v_exp_f32 v51, v51
    v_exp_f32 v52, v52
    v_exp_f32 v53, v53
    s_waitcnt lgkmcnt(3)
    v_mfma_f32_32x32x16_bf16 v[32:47], v[8:11], v[4:7], 0
    s_setprio 1
    v_exp_f32 v54, v54
    v_exp_f32 v55, v55
    v_cvt_pk_bf16_f32 v64, v48, v49
    v_cvt_pk_bf16_f32 v65, v50, v51
    v_cvt_pk_bf16_f32 v66, v52, v53
    v_cvt_pk_bf16_f32 v67, v54, v55
    v_exp_f32 v56, v56
    v_exp_f32 v57, v57
    v_mfma_f32_32x32x16_bf16 v[72:87], v[24:27], v[64:67], v[72:87]
    s_setprio 0
    v_exp_f32 v58, v58
    v_exp_f32 v59, v59
    v_exp_f32 v60, v60
    v_exp_f32 v61, v61
    v_exp_f32 v62, v62
    v_exp_f32 v63, v63
    v_cvt_pk_bf16_f32 v68, v56, v57
    v_cvt_pk_bf16_f32 v69, v58, v59
    v_cvt_pk_bf16_f32 v70, v60, v61
    v_cvt_pk_bf16_f32 v71, v62, v63
    v_exp_f32 v32, v32
    v_exp_f32 v33, v33
    v_mfma_f32_32x32x16_bf16 v[72:87], v[28:31], v[68:71], v[72:87]
    s_mov_b64 exec, s[56:57]
    ds_read_b128 v[24:27], v89 offset:37888
    ds_read_b128 v[28:31], v89 offset:38400
    s_mov_b64 exec, -1
    ds_read_b128 v[8:11], v88 offset:38912
    v_exp_f32 v34, v34
    v_exp_f32 v35, v35
    v_exp_f32 v36, v36
    v_exp_f32 v37, v37
    s_waitcnt lgkmcnt(3)
    v_mfma_f32_32x32x16_bf16 v[48:63], v[12:15], v[4:7], 0
    s_setprio 1
    v_exp_f32 v38, v38
    v_exp_f32 v39, v39
    v_cvt_pk_bf16_f32 v64, v32, v33
    v_cvt_pk_bf16_f32 v65, v34, v35
    v_cvt_pk_bf16_f32 v66, v36, v37
    v_cvt_pk_bf16_f32 v67, v38, v39
    v_exp_f32 v40, v40
    v_exp_f32 v41, v41
    v_mfma_f32_32x32x16_bf16 v[72:87], v[16:19], v[64:67], v[72:87]
    s_setprio 0
    v_exp_f32 v42, v42
    v_exp_f32 v43, v43
    v_exp_f32 v44, v44
    v_exp_f32 v45, v45
    v_exp_f32 v46, v46
    v_exp_f32 v47, v47
    v_cvt_pk_bf16_f32 v68, v40, v41
    v_cvt_pk_bf16_f32 v69, v42, v43
    v_cvt_pk_bf16_f32 v70, v44, v45
    v_cvt_pk_bf16_f32 v71, v46, v47
    v_exp_f32 v48, v48
    v_exp_f32 v49, v49
    v_mfma_f32_32x32x16_bf16 v[72:87], v[20:23], v[68:71], v[72:87]
    s_mov_b64 exec, s[56:57]
    ds_read_b128 v[16:19], v89 offset:38912
    ds_read_b128 v[20:23], v89 offset:39424
    s_mov_b64 exec, -1
    ds_read_b128 v[12:15], v88 offset:39936
    v_exp_f32 v50, v50
    v_exp_f32 v51, v51
    v_exp_f32 v52, v52
    v_exp_f32 v53, v53
    s_waitcnt lgkmcnt(3)
    v_mfma_f32_32x32x16_bf16 v[32:47], v[8:11], v[4:7], 0
    s_setprio 1
    v_exp_f32 v54, v54
    v_exp_f32 v55, v55
    v_cvt_pk_bf16_f32 v64, v48, v49
    v_cvt_pk_bf16_f32 v65, v50, v51
    v_cvt_pk_bf16_f32 v66, v52, v53
    v_cvt_pk_bf16_f32 v67, v54, v55
    v_exp_f32 v56, v56
    v_exp_f32 v57, v57
    v_mfma_f32_32x32x16_bf16 v[72:87], v[24:27], v[64:67], v[72:87]
    s_setprio 0
    v_exp_f32 v58, v58
    v_exp_f32 v59, v59
    v_exp_f32 v60, v60
    v_exp_f32 v61, v61
    v_exp_f32 v62, v62
    v_exp_f32 v63, v63
    v_cvt_pk_bf16_f32 v68, v56, v57
    v_cvt_pk_bf16_f32 v69, v58, v59
    v_cvt_pk_bf16_f32 v70, v60, v61
    v_cvt_pk_bf16_f32 v71, v62, v63
    v_exp_f32 v32, v32
    v_exp_f32 v33, v33
    v_mfma_f32_32x32x16_bf16 v[72:87], v[28:31], v[68:71], v[72:87]
    s_mov_b64 exec, s[56:57]
    ds_read_b128 v[24:27], v89 offset:39936
    ds_read_b128 v[28:31], v89 offset:40448
    s_mov_b64 exec, -1
    ds_read_b128 v[8:11], v88 offset:40960
    v_exp_f32 v34, v34
    v_exp_f32 v35, v35
    v_exp_f32 v36, v36
    v_exp_f32 v37, v37
    s_waitcnt lgkmcnt(3)
    v_mfma_f32_32x32x16_bf16 v[48:63], v[12:15], v[4:7], 0
    s_setprio 1
    v_exp_f32 v38, v38
    v_exp_f32 v39, v39
    v_cvt_pk_bf16_f32 v64, v32, v33
    v_cvt_pk_bf16_f32 v65, v34, v35
    v_cvt_pk_bf16_f32 v66, v36, v37
    v_cvt_pk_bf16_f32 v67, v38, v39
    v_exp_f32 v40, v40
    v_exp_f32 v41, v41
    v_mfma_f32_32x32x16_bf16 v[72:87], v[16:19], v[64:67], v[72:87]
    s_setprio 0
    v_exp_f32 v42, v42
    v_exp_f32 v43, v43
    v_exp_f32 v44, v44
    v_exp_f32 v45, v45
    v_exp_f32 v46, v46
    v_exp_f32 v47, v47
    v_cvt_pk_bf16_f32 v68, v40, v41
    v_cvt_pk_bf16_f32 v69, v42, v43
    v_cvt_pk_bf16_f32 v70, v44, v45
    v_cvt_pk_bf16_f32 v71, v46, v47
    s_waitcnt vmcnt(0)
    ds_read_b64_tr_b16 v[192:193], v93 offset:0
    ds_read_b64_tr_b16 v[194:195], v93 offset:1024
    ds_read_b64_tr_b16 v[196:197], v94 offset:0
    ds_read_b64_tr_b16 v[198:199], v94 offset:1024
    ds_read_b64_tr_b16 v[200:201], v93 offset:2048
    ds_read_b64_tr_b16 v[202:203], v93 offset:3072
    ds_read_b64_tr_b16 v[204:205], v94 offset:2048
    ds_read_b64_tr_b16 v[206:207], v94 offset:3072
    v_exp_f32 v48, v48
    v_exp_f32 v49, v49
    v_mfma_f32_32x32x16_bf16 v[72:87], v[20:23], v[68:71], v[72:87]
    s_mov_b64 exec, s[56:57]
    ds_read_b128 v[16:19], v89 offset:40960
    ds_read_b128 v[20:23], v89 offset:41472
    s_mov_b64 exec, -1
    ds_read_b128 v[12:15], v88 offset:41984
    v_exp_f32 v50, v50
    v_exp_f32 v51, v51
    v_exp_f32 v52, v52
    v_exp_f32 v53, v53
    s_waitcnt lgkmcnt(3)
    v_mfma_f32_32x32x16_bf16 v[32:47], v[8:11], v[4:7], 0
    s_setprio 1
    v_exp_f32 v54, v54
    v_exp_f32 v55, v55
    v_cvt_pk_bf16_f32 v64, v48, v49
    v_cvt_pk_bf16_f32 v65, v50, v51
    v_cvt_pk_bf16_f32 v66, v52, v53
    v_cvt_pk_bf16_f32 v67, v54, v55
    v_exp_f32 v56, v56
    v_exp_f32 v57, v57
    v_mfma_f32_32x32x16_bf16 v[72:87], v[24:27], v[64:67], v[72:87]
    s_setprio 0
    v_exp_f32 v58, v58
    v_exp_f32 v59, v59
    v_exp_f32 v60, v60
    v_exp_f32 v61, v61
    v_exp_f32 v62, v62
    v_exp_f32 v63, v63
    v_cvt_pk_bf16_f32 v68, v56, v57
    v_cvt_pk_bf16_f32 v69, v58, v59
    v_cvt_pk_bf16_f32 v70, v60, v61
    v_cvt_pk_bf16_f32 v71, v62, v63
    s_mov_b32 m0, s59
    s_mov_b32 s60, 573440
    buffer_load_dwordx4 v92, s[28:31], s60 offen lds
    buffer_load_dwordx4 v117, s[28:31], s60 offen offset:1024 lds
    buffer_load_dwordx4 v118, s[28:31], s60 offen offset:2048 lds
    buffer_load_dwordx4 v119, s[28:31], s60 offen offset:3072 lds
    v_exp_f32 v32, v32
    v_exp_f32 v33, v33
    v_mfma_f32_32x32x16_bf16 v[72:87], v[28:31], v[68:71], v[72:87]
    s_mov_b64 exec, s[56:57]
    ds_read_b128 v[24:27], v89 offset:41984
    ds_read_b128 v[28:31], v89 offset:42496
    s_mov_b64 exec, -1
    ds_read_b128 v[8:11], v88 offset:43008
    v_exp_f32 v34, v34
    v_exp_f32 v35, v35
    v_exp_f32 v36, v36
    v_exp_f32 v37, v37
    s_waitcnt lgkmcnt(3)
    v_mfma_f32_32x32x16_bf16 v[48:63], v[12:15], v[4:7], 0
    s_setprio 1
    v_exp_f32 v38, v38
    v_exp_f32 v39, v39
    v_cvt_pk_bf16_f32 v64, v32, v33
    v_cvt_pk_bf16_f32 v65, v34, v35
    v_cvt_pk_bf16_f32 v66, v36, v37
    v_cvt_pk_bf16_f32 v67, v38, v39
    v_exp_f32 v40, v40
    v_exp_f32 v41, v41
    v_mfma_f32_32x32x16_bf16 v[72:87], v[16:19], v[64:67], v[72:87]
    s_setprio 0
    v_exp_f32 v42, v42
    v_exp_f32 v43, v43
    v_exp_f32 v44, v44
    v_exp_f32 v45, v45
    v_exp_f32 v46, v46
    v_exp_f32 v47, v47
    v_cvt_pk_bf16_f32 v68, v40, v41
    v_cvt_pk_bf16_f32 v69, v42, v43
    v_cvt_pk_bf16_f32 v70, v44, v45
    v_cvt_pk_bf16_f32 v71, v46, v47
    v_exp_f32 v48, v48
    v_exp_f32 v49, v49
    v_mfma_f32_32x32x16_bf16 v[72:87], v[20:23], v[68:71], v[72:87]
    s_mov_b64 exec, s[56:57]
    ds_read_b128 v[16:19], v89 offset:43008
    ds_read_b128 v[20:23], v89 offset:43520
    s_mov_b64 exec, -1
    ds_read_b128 v[12:15], v88 offset:44032
    v_exp_f32 v50, v50
    v_exp_f32 v51, v51
    v_exp_f32 v52, v52
    v_exp_f32 v53, v53
    s_waitcnt lgkmcnt(3)
    v_mfma_f32_32x32x16_bf16 v[32:47], v[8:11], v[4:7], 0
    s_setprio 1
    v_exp_f32 v54, v54
    v_exp_f32 v55, v55
    v_cvt_pk_bf16_f32 v64, v48, v49
    v_cvt_pk_bf16_f32 v65, v50, v51
    v_cvt_pk_bf16_f32 v66, v52, v53
    v_cvt_pk_bf16_f32 v67, v54, v55
    v_exp_f32 v56, v56
    v_exp_f32 v57, v57
    v_mfma_f32_32x32x16_bf16 v[72:87], v[24:27], v[64:67], v[72:87]
    s_setprio 0
    v_exp_f32 v58, v58
    v_exp_f32 v59, v59
    v_exp_f32 v60, v60
    v_exp_f32 v61, v61
    v_exp_f32 v62, v62
    v_exp_f32 v63, v63
    v_cvt_pk_bf16_f32 v68, v56, v57
    v_cvt_pk_bf16_f32 v69, v58, v59
    v_cvt_pk_bf16_f32 v70, v60, v61
    v_cvt_pk_bf16_f32 v71, v62, v63
    v_exp_f32 v32, v32
    v_exp_f32 v33, v33
    v_mfma_f32_32x32x16_bf16 v[72:87], v[28:31], v[68:71], v[72:87]
    s_mov_b64 exec, s[56:57]
    ds_read_b128 v[24:27], v89 offset:44032
    ds_read_b128 v[28:31], v89 offset:44544
    s_mov_b64 exec, -1
    ds_read_b128 v[8:11], v88 offset:45056
    v_exp_f32 v34, v34
    v_exp_f32 v35, v35
    v_exp_f32 v36, v36
    v_exp_f32 v37, v37
    s_waitcnt lgkmcnt(3)
    v_mfma_f32_32x32x16_bf16 v[48:63], v[12:15], v[4:7], 0
    s_setprio 1
    v_exp_f32 v38, v38
    v_exp_f32 v39, v39
    v_cvt_pk_bf16_f32 v64, v32, v33
    v_cvt_pk_bf16_f32 v65, v34, v35
    v_cvt_pk_bf16_f32 v66, v36, v37
    v_cvt_pk_bf16_f32 v67, v38, v39
    v_exp_f32 v40, v40
    v_exp_f32 v41, v41
    v_mfma_f32_32x32x16_bf16 v[72:87], v[16:19], v[64:67], v[72:87]
    s_setprio 0
    v_exp_f32 v42, v42
    v_exp_f32 v43, v43
    v_exp_f32 v44, v44
    v_exp_f32 v45, v45
    v_exp_f32 v46, v46
    v_exp_f32 v47, v47
    v_cvt_pk_bf16_f32 v68, v40, v41
    v_cvt_pk_bf16_f32 v69, v42, v43
    v_cvt_pk_bf16_f32 v70, v44, v45
    v_cvt_pk_bf16_f32 v71, v46, v47
    v_exp_f32 v48, v48
    v_exp_f32 v49, v49
    v_mfma_f32_32x32x16_bf16 v[72:87], v[20:23], v[68:71], v[72:87]
    s_mov_b64 exec, s[56:57]
    ds_read_b128 v[16:19], v89 offset:45056
    ds_read_b128 v[20:23], v89 offset:45568
    s_mov_b64 exec, -1
    ds_read_b128 v[12:15], v88 offset:46080
    v_exp_f32 v50, v50
    v_exp_f32 v51, v51
    v_exp_f32 v52, v52
    v_exp_f32 v53, v53
    s_waitcnt lgkmcnt(3)
    v_mfma_f32_32x32x16_bf16 v[32:47], v[8:11], v[4:7], 0
    s_setprio 1
    v_exp_f32 v54, v54
    v_exp_f32 v55, v55
    v_cvt_pk_bf16_f32 v64, v48, v49
    v_cvt_pk_bf16_f32 v65, v50, v51
    v_cvt_pk_bf16_f32 v66, v52, v53
    v_cvt_pk_bf16_f32 v67, v54, v55
    v_exp_f32 v56, v56
    v_exp_f32 v57, v57
    v_mfma_f32_32x32x16_bf16 v[72:87], v[24:27], v[64:67], v[72:87]
    s_setprio 0
    v_exp_f32 v58, v58
    v_exp_f32 v59, v59
    v_exp_f32 v60, v60
    v_exp_f32 v61, v61
    v_exp_f32 v62, v62
    v_exp_f32 v63, v63
    v_cvt_pk_bf16_f32 v68, v56, v57
    v_cvt_pk_bf16_f32 v69, v58, v59
    v_cvt_pk_bf16_f32 v70, v60, v61
    v_cvt_pk_bf16_f32 v71, v62, v63
    s_barrier
    v_exp_f32 v32, v32
    v_exp_f32 v33, v33
    v_mfma_f32_32x32x16_bf16 v[72:87], v[28:31], v[68:71], v[72:87]
    s_mov_b64 exec, s[56:57]
    ds_read_b128 v[24:27], v89 offset:46080
    ds_read_b128 v[28:31], v89 offset:46592
    s_mov_b64 exec, -1
    ds_read_b128 v[8:11], v88 offset:47104
    v_exp_f32 v34, v34
    v_exp_f32 v35, v35
    v_exp_f32 v36, v36
    v_exp_f32 v37, v37
    s_waitcnt lgkmcnt(3)
    v_mfma_f32_32x32x16_bf16 v[48:63], v[12:15], v[4:7], 0
    s_setprio 1
    v_exp_f32 v38, v38
    v_exp_f32 v39, v39
    v_cvt_pk_bf16_f32 v64, v32, v33
    v_cvt_pk_bf16_f32 v65, v34, v35
    v_cvt_pk_bf16_f32 v66, v36, v37
    v_cvt_pk_bf16_f32 v67, v38, v39
    v_exp_f32 v40, v40
    v_exp_f32 v41, v41
    v_mfma_f32_32x32x16_bf16 v[72:87], v[16:19], v[64:67], v[72:87]
    s_setprio 0
    v_exp_f32 v42, v42
    v_exp_f32 v43, v43
    v_exp_f32 v44, v44
    v_exp_f32 v45, v45
    v_exp_f32 v46, v46
    v_exp_f32 v47, v47
    v_cvt_pk_bf16_f32 v68, v40, v41
    v_cvt_pk_bf16_f32 v69, v42, v43
    v_cvt_pk_bf16_f32 v70, v44, v45
    v_cvt_pk_bf16_f32 v71, v46, v47
    s_mov_b32 m0, s53
    s_mov_b32 s60, 0
    buffer_load_dwordx4 v95, s[40:43], s60 offen lds
    s_add_u32 m0, s53, 1024
    s_mov_b32 s60, 8192
    buffer_load_dwordx4 v95, s[40:43], s60 offen lds
    s_add_u32 m0, s53, 2048
    s_mov_b32 s60, 16384
    buffer_load_dwordx4 v95, s[40:43], s60 offen lds
    s_add_u32 m0, s53, 3072
    s_mov_b32 s60, 24576
    buffer_load_dwordx4 v95, s[40:43], s60 offen lds
    v_exp_f32 v48, v48
    v_exp_f32 v49, v49
    v_mfma_f32_32x32x16_bf16 v[72:87], v[20:23], v[68:71], v[72:87]
    s_mov_b64 exec, s[56:57]
    ds_read_b128 v[16:19], v89 offset:47104
    ds_read_b128 v[20:23], v89 offset:47616
    s_mov_b64 exec, -1
    ds_read_b128 v[12:15], v88 offset:48128
    v_exp_f32 v50, v50
    v_exp_f32 v51, v51
    v_exp_f32 v52, v52
    v_exp_f32 v53, v53
    s_waitcnt lgkmcnt(3)
    v_mfma_f32_32x32x16_bf16 v[32:47], v[8:11], v[4:7], 0
    s_setprio 1
    v_exp_f32 v54, v54
    v_exp_f32 v55, v55
    v_cvt_pk_bf16_f32 v64, v48, v49
    v_cvt_pk_bf16_f32 v65, v50, v51
    v_cvt_pk_bf16_f32 v66, v52, v53
    v_cvt_pk_bf16_f32 v67, v54, v55
    v_exp_f32 v56, v56
    v_exp_f32 v57, v57
    v_mfma_f32_32x32x16_bf16 v[72:87], v[24:27], v[64:67], v[72:87]
    s_setprio 0
    v_exp_f32 v58, v58
    v_exp_f32 v59, v59
    v_exp_f32 v60, v60
    v_exp_f32 v61, v61
    v_exp_f32 v62, v62
    v_exp_f32 v63, v63
    v_cvt_pk_bf16_f32 v68, v56, v57
    v_cvt_pk_bf16_f32 v69, v58, v59
    v_cvt_pk_bf16_f32 v70, v60, v61
    v_cvt_pk_bf16_f32 v71, v62, v63
    s_add_u32 m0, s53, 4096
    s_mov_b32 s60, 32768
    buffer_load_dwordx4 v95, s[40:43], s60 offen lds
    s_add_u32 m0, s53, 5120
    s_mov_b32 s60, 40960
    buffer_load_dwordx4 v95, s[40:43], s60 offen lds
    s_add_u32 m0, s53, 6144
    s_mov_b32 s60, 49152
    buffer_load_dwordx4 v95, s[40:43], s60 offen lds
    s_add_u32 m0, s53, 7168
    s_mov_b32 s60, 57344
    buffer_load_dwordx4 v95, s[40:43], s60 offen lds
    v_exp_f32 v32, v32
    v_exp_f32 v33, v33
    v_mfma_f32_32x32x16_bf16 v[72:87], v[28:31], v[68:71], v[72:87]
    s_mov_b64 exec, s[56:57]
    ds_read_b128 v[24:27], v89 offset:48128
    ds_read_b128 v[28:31], v89 offset:48640
    s_mov_b64 exec, -1
    ds_read_b128 v[8:11], v88 offset:49152
    v_exp_f32 v34, v34
    v_exp_f32 v35, v35
    v_exp_f32 v36, v36
    v_exp_f32 v37, v37
    s_waitcnt lgkmcnt(3)
    v_mfma_f32_32x32x16_bf16 v[48:63], v[12:15], v[4:7], 0
    s_setprio 1
    v_exp_f32 v38, v38
    v_exp_f32 v39, v39
    v_cvt_pk_bf16_f32 v64, v32, v33
    v_cvt_pk_bf16_f32 v65, v34, v35
    v_cvt_pk_bf16_f32 v66, v36, v37
    v_cvt_pk_bf16_f32 v67, v38, v39
    v_exp_f32 v40, v40
    v_exp_f32 v41, v41
    v_mfma_f32_32x32x16_bf16 v[72:87], v[16:19], v[64:67], v[72:87]
    s_setprio 0
    v_exp_f32 v42, v42
    v_exp_f32 v43, v43
    v_exp_f32 v44, v44
    v_exp_f32 v45, v45
    v_exp_f32 v46, v46
    v_exp_f32 v47, v47
    v_cvt_pk_bf16_f32 v68, v40, v41
    v_cvt_pk_bf16_f32 v69, v42, v43
    v_cvt_pk_bf16_f32 v70, v44, v45
    v_cvt_pk_bf16_f32 v71, v46, v47
    s_waitcnt vmcnt(8)
    ds_read_b64_tr_b16 v[208:209], v93 offset:0
    ds_read_b64_tr_b16 v[210:211], v93 offset:1024
    ds_read_b64_tr_b16 v[212:213], v94 offset:0
    ds_read_b64_tr_b16 v[214:215], v94 offset:1024
    ds_read_b64_tr_b16 v[216:217], v93 offset:2048
    ds_read_b64_tr_b16 v[218:219], v93 offset:3072
    ds_read_b64_tr_b16 v[220:221], v94 offset:2048
    ds_read_b64_tr_b16 v[222:223], v94 offset:3072
    v_exp_f32 v48, v48
    v_exp_f32 v49, v49
    v_mfma_f32_32x32x16_bf16 v[72:87], v[20:23], v[68:71], v[72:87]
    s_mov_b64 exec, s[56:57]
    ds_read_b128 v[16:19], v89 offset:49152
    ds_read_b128 v[20:23], v89 offset:49664
    s_mov_b64 exec, -1
    ds_read_b128 v[12:15], v88 offset:50176
    v_exp_f32 v50, v50
    v_exp_f32 v51, v51
    v_exp_f32 v52, v52
    v_exp_f32 v53, v53
    s_waitcnt lgkmcnt(3)
    v_mfma_f32_32x32x16_bf16 v[32:47], v[8:11], v[4:7], 0
    s_setprio 1
    v_exp_f32 v54, v54
    v_exp_f32 v55, v55
    v_cvt_pk_bf16_f32 v64, v48, v49
    v_cvt_pk_bf16_f32 v65, v50, v51
    v_cvt_pk_bf16_f32 v66, v52, v53
    v_cvt_pk_bf16_f32 v67, v54, v55
    v_exp_f32 v56, v56
    v_exp_f32 v57, v57
    v_mfma_f32_32x32x16_bf16 v[72:87], v[24:27], v[64:67], v[72:87]
    s_setprio 0
    v_exp_f32 v58, v58
    v_exp_f32 v59, v59
    v_exp_f32 v60, v60
    v_exp_f32 v61, v61
    v_exp_f32 v62, v62
    v_exp_f32 v63, v63
    v_cvt_pk_bf16_f32 v68, v56, v57
    v_cvt_pk_bf16_f32 v69, v58, v59
    v_cvt_pk_bf16_f32 v70, v60, v61
    v_cvt_pk_bf16_f32 v71, v62, v63
    s_mov_b32 m0, s59
    s_mov_b32 s60, 688128
    buffer_load_dwordx4 v92, s[28:31], s60 offen lds
    buffer_load_dwordx4 v117, s[28:31], s60 offen offset:1024 lds
    buffer_load_dwordx4 v118, s[28:31], s60 offen offset:2048 lds
    buffer_load_dwordx4 v119, s[28:31], s60 offen offset:3072 lds
    v_exp_f32 v32, v32
    v_exp_f32 v33, v33
    v_mfma_f32_32x32x16_bf16 v[72:87], v[28:31], v[68:71], v[72:87]
    s_mov_b64 exec, s[56:57]
    ds_read_b128 v[24:27], v89 offset:50176
    ds_read_b128 v[28:31], v89 offset:50688
    s_mov_b64 exec, -1
    ds_read_b128 v[8:11], v88 offset:51200
    v_exp_f32 v34, v34
    v_exp_f32 v35, v35
    v_exp_f32 v36, v36
    v_exp_f32 v37, v37
    s_waitcnt lgkmcnt(3)
    v_mfma_f32_32x32x16_bf16 v[48:63], v[12:15], v[4:7], 0
    s_setprio 1
    v_exp_f32 v38, v38
    v_exp_f32 v39, v39
    v_cvt_pk_bf16_f32 v64, v32, v33
    v_cvt_pk_bf16_f32 v65, v34, v35
    v_cvt_pk_bf16_f32 v66, v36, v37
    v_cvt_pk_bf16_f32 v67, v38, v39
    v_exp_f32 v40, v40
    v_exp_f32 v41, v41
    v_mfma_f32_32x32x16_bf16 v[72:87], v[16:19], v[64:67], v[72:87]
    s_setprio 0
    v_exp_f32 v42, v42
    v_exp_f32 v43, v43
    v_exp_f32 v44, v44
    v_exp_f32 v45, v45
    v_exp_f32 v46, v46
    v_exp_f32 v47, v47
    v_cvt_pk_bf16_f32 v68, v40, v41
    v_cvt_pk_bf16_f32 v69, v42, v43
    v_cvt_pk_bf16_f32 v70, v44, v45
    v_cvt_pk_bf16_f32 v71, v46, v47
    v_exp_f32 v48, v48
    v_exp_f32 v49, v49
    v_mfma_f32_32x32x16_bf16 v[72:87], v[20:23], v[68:71], v[72:87]
    s_mov_b64 exec, s[56:57]
    ds_read_b128 v[16:19], v89 offset:51200
    ds_read_b128 v[20:23], v89 offset:51712
    s_mov_b64 exec, -1
    ds_read_b128 v[12:15], v88 offset:52224
    v_exp_f32 v50, v50
    v_exp_f32 v51, v51
    v_exp_f32 v52, v52
    v_exp_f32 v53, v53
    s_waitcnt lgkmcnt(3)
    v_mfma_f32_32x32x16_bf16 v[32:47], v[8:11], v[4:7], 0
    s_setprio 1
    v_exp_f32 v54, v54
    v_exp_f32 v55, v55
    v_cvt_pk_bf16_f32 v64, v48, v49
    v_cvt_pk_bf16_f32 v65, v50, v51
    v_cvt_pk_bf16_f32 v66, v52, v53
    v_cvt_pk_bf16_f32 v67, v54, v55
    v_exp_f32 v56, v56
    v_exp_f32 v57, v57
    v_mfma_f32_32x32x16_bf16 v[72:87], v[24:27], v[64:67], v[72:87]
    s_setprio 0
    v_exp_f32 v58, v58
    v_exp_f32 v59, v59
    v_exp_f32 v60, v60
    v_exp_f32 v61, v61
    v_exp_f32 v62, v62
    v_exp_f32 v63, v63
    v_cvt_pk_bf16_f32 v68, v56, v57
    v_cvt_pk_bf16_f32 v69, v58, v59
    v_cvt_pk_bf16_f32 v70, v60, v61
    v_cvt_pk_bf16_f32 v71, v62, v63
    v_exp_f32 v32, v32
    v_exp_f32 v33, v33
    v_mfma_f32_32x32x16_bf16 v[72:87], v[28:31], v[68:71], v[72:87]
    s_mov_b64 exec, s[56:57]
    ds_read_b128 v[24:27], v89 offset:52224
    ds_read_b128 v[28:31], v89 offset:52736
    s_mov_b64 exec, -1
    ds_read_b128 v[8:11], v88 offset:53248
    v_exp_f32 v34, v34
    v_exp_f32 v35, v35
    v_exp_f32 v36, v36
    v_exp_f32 v37, v37
    s_waitcnt lgkmcnt(3)
    v_mfma_f32_32x32x16_bf16 v[48:63], v[12:15], v[4:7], 0
    s_setprio 1
    v_exp_f32 v38, v38
    v_exp_f32 v39, v39
    v_cvt_pk_bf16_f32 v64, v32, v33
    v_cvt_pk_bf16_f32 v65, v34, v35
    v_cvt_pk_bf16_f32 v66, v36, v37
    v_cvt_pk_bf16_f32 v67, v38, v39
    v_exp_f32 v40, v40
    v_exp_f32 v41, v41
    v_mfma_f32_32x32x16_bf16 v[72:87], v[16:19], v[64:67], v[72:87]
    s_setprio 0
    v_exp_f32 v42, v42
    v_exp_f32 v43, v43
    v_exp_f32 v44, v44
    v_exp_f32 v45, v45
    v_exp_f32 v46, v46
    v_exp_f32 v47, v47
    v_cvt_pk_bf16_f32 v68, v40, v41
    v_cvt_pk_bf16_f32 v69, v42, v43
    v_cvt_pk_bf16_f32 v70, v44, v45
    v_cvt_pk_bf16_f32 v71, v46, v47
    v_exp_f32 v48, v48
    v_exp_f32 v49, v49
    v_mfma_f32_32x32x16_bf16 v[72:87], v[20:23], v[68:71], v[72:87]
    s_mov_b64 exec, s[56:57]
    ds_read_b128 v[16:19], v89 offset:53248
    ds_read_b128 v[20:23], v89 offset:53760
    s_mov_b64 exec, -1
    ds_read_b128 v[12:15], v88 offset:54272
    v_exp_f32 v50, v50
    v_exp_f32 v51, v51
    v_exp_f32 v52, v52
    v_exp_f32 v53, v53
    s_waitcnt lgkmcnt(3)
    v_mfma_f32_32x32x16_bf16 v[32:47], v[8:11], v[4:7], 0
    s_setprio 1
    v_exp_f32 v54, v54
    v_exp_f32 v55, v55
    v_cvt_pk_bf16_f32 v64, v48, v49
    v_cvt_pk_bf16_f32 v65, v50, v51
    v_cvt_pk_bf16_f32 v66, v52, v53
    v_cvt_pk_bf16_f32 v67, v54, v55
    v_exp_f32 v56, v56
    v_exp_f32 v57, v57
    v_mfma_f32_32x32x16_bf16 v[72:87], v[24:27], v[64:67], v[72:87]
    s_setprio 0
    v_exp_f32 v58, v58
    v_exp_f32 v59, v59
    v_exp_f32 v60, v60
    v_exp_f32 v61, v61
    v_exp_f32 v62, v62
    v_exp_f32 v63, v63
    v_cvt_pk_bf16_f32 v68, v56, v57
    v_cvt_pk_bf16_f32 v69, v58, v59
    v_cvt_pk_bf16_f32 v70, v60, v61
    v_cvt_pk_bf16_f32 v71, v62, v63
    s_cmp_lg_u32 s3, 0
    s_cbranch_scc1 L_lc_13
    s_mov_b32 s60, 14944256
    buffer_load_dword v113, v112, s[68:71], s60 offen sc1
L_lc_13:
    v_exp_f32 v32, v32
    v_exp_f32 v33, v33
    v_mfma_f32_32x32x16_bf16 v[72:87], v[28:31], v[68:71], v[72:87]
    s_mov_b64 exec, s[56:57]
    ds_read_b128 v[24:27], v89 offset:54272
    ds_read_b128 v[28:31], v89 offset:54784
    s_mov_b64 exec, -1
    ds_read_b128 v[8:11], v88 offset:55296
    v_exp_f32 v34, v34
    v_exp_f32 v35, v35
    v_exp_f32 v36, v36
    v_exp_f32 v37, v37
    s_waitcnt lgkmcnt(3)
    v_mfma_f32_32x32x16_bf16 v[48:63], v[12:15], v[4:7], 0
    s_setprio 1
    v_exp_f32 v38, v38
    v_exp_f32 v39, v39
    v_cvt_pk_bf16_f32 v64, v32, v33
    v_cvt_pk_bf16_f32 v65, v34, v35
    v_cvt_pk_bf16_f32 v66, v36, v37
    v_cvt_pk_bf16_f32 v67, v38, v39
    v_exp_f32 v40, v40
    v_exp_f32 v41, v41
    v_mfma_f32_32x32x16_bf16 v[72:87], v[16:19], v[64:67], v[72:87]
    s_setprio 0
    v_exp_f32 v42, v42
    v_exp_f32 v43, v43
    v_exp_f32 v44, v44
    v_exp_f32 v45, v45
    v_exp_f32 v46, v46
    v_exp_f32 v47, v47
    v_cvt_pk_bf16_f32 v68, v40, v41
    v_cvt_pk_bf16_f32 v69, v42, v43
    v_cvt_pk_bf16_f32 v70, v44, v45
    v_cvt_pk_bf16_f32 v71, v46, v47
    v_exp_f32 v48, v48
    v_exp_f32 v49, v49
    v_mfma_f32_32x32x16_bf16 v[72:87], v[20:23], v[68:71], v[72:87]
    s_mov_b64 exec, s[56:57]
    ds_read_b128 v[16:19], v89 offset:55296
    ds_read_b128 v[20:23], v89 offset:55808
    s_mov_b64 exec, -1
    ds_read_b128 v[12:15], v88 offset:56320
    v_exp_f32 v50, v50
    v_exp_f32 v51, v51
    v_exp_f32 v52, v52
    v_exp_f32 v53, v53
    s_waitcnt lgkmcnt(3)
    v_mfma_f32_32x32x16_bf16 v[32:47], v[8:11], v[4:7], 0
    s_setprio 1
    v_exp_f32 v54, v54
    v_exp_f32 v55, v55
    v_cvt_pk_bf16_f32 v64, v48, v49
    v_cvt_pk_bf16_f32 v65, v50, v51
    v_cvt_pk_bf16_f32 v66, v52, v53
    v_cvt_pk_bf16_f32 v67, v54, v55
    v_exp_f32 v56, v56
    v_exp_f32 v57, v57
    v_mfma_f32_32x32x16_bf16 v[72:87], v[24:27], v[64:67], v[72:87]
    s_setprio 0
    v_exp_f32 v58, v58
    v_exp_f32 v59, v59
    v_exp_f32 v60, v60
    v_exp_f32 v61, v61
    v_exp_f32 v62, v62
    v_exp_f32 v63, v63
    v_cvt_pk_bf16_f32 v68, v56, v57
    v_cvt_pk_bf16_f32 v69, v58, v59
    v_cvt_pk_bf16_f32 v70, v60, v61
    v_cvt_pk_bf16_f32 v71, v62, v63
    v_exp_f32 v32, v32
    v_exp_f32 v33, v33
    v_mfma_f32_32x32x16_bf16 v[72:87], v[28:31], v[68:71], v[72:87]
    s_mov_b64 exec, s[56:57]
    ds_read_b128 v[24:27], v89 offset:56320
    ds_read_b128 v[28:31], v89 offset:56832
    s_mov_b64 exec, -1
    ds_read_b128 v[8:11], v88 offset:57344
    v_exp_f32 v34, v34
    v_exp_f32 v35, v35
    v_exp_f32 v36, v36
    v_exp_f32 v37, v37
    s_waitcnt lgkmcnt(3)
    v_mfma_f32_32x32x16_bf16 v[48:63], v[12:15], v[4:7], 0
    s_setprio 1
    v_exp_f32 v38, v38
    v_exp_f32 v39, v39
    v_cvt_pk_bf16_f32 v64, v32, v33
    v_cvt_pk_bf16_f32 v65, v34, v35
    v_cvt_pk_bf16_f32 v66, v36, v37
    v_cvt_pk_bf16_f32 v67, v38, v39
    v_exp_f32 v40, v40
    v_exp_f32 v41, v41
    v_mfma_f32_32x32x16_bf16 v[72:87], v[16:19], v[64:67], v[72:87]
    s_setprio 0
    v_exp_f32 v42, v42
    v_exp_f32 v43, v43
    v_exp_f32 v44, v44
    v_exp_f32 v45, v45
    v_exp_f32 v46, v46
    v_exp_f32 v47, v47
    v_cvt_pk_bf16_f32 v68, v40, v41
    v_cvt_pk_bf16_f32 v69, v42, v43
    v_cvt_pk_bf16_f32 v70, v44, v45
    v_cvt_pk_bf16_f32 v71, v46, v47
    s_waitcnt vmcnt(0)
    ds_read_b64_tr_b16 v[224:225], v93 offset:0
    ds_read_b64_tr_b16 v[226:227], v93 offset:1024
    ds_read_b64_tr_b16 v[228:229], v94 offset:0
    ds_read_b64_tr_b16 v[230:231], v94 offset:1024
    ds_read_b64_tr_b16 v[232:233], v93 offset:2048
    ds_read_b64_tr_b16 v[234:235], v93 offset:3072
    ds_read_b64_tr_b16 v[236:237], v94 offset:2048
    ds_read_b64_tr_b16 v[238:239], v94 offset:3072
    v_exp_f32 v48, v48
    v_exp_f32 v49, v49
    v_mfma_f32_32x32x16_bf16 v[72:87], v[20:23], v[68:71], v[72:87]
    s_mov_b64 exec, s[56:57]
    ds_read_b128 v[16:19], v89 offset:57344
    ds_read_b128 v[20:23], v89 offset:57856
    s_mov_b64 exec, -1
    ds_read_b128 v[12:15], v88 offset:58368
    v_exp_f32 v50, v50
    v_exp_f32 v51, v51
    v_exp_f32 v52, v52
    v_exp_f32 v53, v53
    s_waitcnt lgkmcnt(3)
    v_mfma_f32_32x32x16_bf16 v[32:47], v[8:11], v[4:7], 0
    s_setprio 1
    v_exp_f32 v54, v54
    v_exp_f32 v55, v55
    v_cvt_pk_bf16_f32 v64, v48, v49
    v_cvt_pk_bf16_f32 v65, v50, v51
    v_cvt_pk_bf16_f32 v66, v52, v53
    v_cvt_pk_bf16_f32 v67, v54, v55
    v_exp_f32 v56, v56
    v_exp_f32 v57, v57
    v_mfma_f32_32x32x16_bf16 v[72:87], v[24:27], v[64:67], v[72:87]
    s_setprio 0
    v_exp_f32 v58, v58
    v_exp_f32 v59, v59
    v_exp_f32 v60, v60
    v_exp_f32 v61, v61
    v_exp_f32 v62, v62
    v_exp_f32 v63, v63
    v_cvt_pk_bf16_f32 v68, v56, v57
    v_cvt_pk_bf16_f32 v69, v58, v59
    v_cvt_pk_bf16_f32 v70, v60, v61
    v_cvt_pk_bf16_f32 v71, v62, v63
    s_mov_b32 m0, s59
    s_mov_b32 s60, 802816
    buffer_load_dwordx4 v92, s[28:31], s60 offen lds
    buffer_load_dwordx4 v117, s[28:31], s60 offen offset:1024 lds
    buffer_load_dwordx4 v118, s[28:31], s60 offen offset:2048 lds
    buffer_load_dwordx4 v119, s[28:31], s60 offen offset:3072 lds
    v_exp_f32 v32, v32
    v_exp_f32 v33, v33
    v_mfma_f32_32x32x16_bf16 v[72:87], v[28:31], v[68:71], v[72:87]
    s_mov_b64 exec, s[56:57]
    ds_read_b128 v[24:27], v89 offset:58368
    ds_read_b128 v[28:31], v89 offset:58880
    s_mov_b64 exec, -1
    ds_read_b128 v[8:11], v88 offset:59392
    v_exp_f32 v34, v34
    v_exp_f32 v35, v35
    v_exp_f32 v36, v36
    v_exp_f32 v37, v37
    s_waitcnt lgkmcnt(3)
    v_mfma_f32_32x32x16_bf16 v[48:63], v[12:15], v[4:7], 0
    s_setprio 1
    v_exp_f32 v38, v38
    v_exp_f32 v39, v39
    v_cvt_pk_bf16_f32 v64, v32, v33
    v_cvt_pk_bf16_f32 v65, v34, v35
    v_cvt_pk_bf16_f32 v66, v36, v37
    v_cvt_pk_bf16_f32 v67, v38, v39
    v_exp_f32 v40, v40
    v_exp_f32 v41, v41
    v_mfma_f32_32x32x16_bf16 v[72:87], v[16:19], v[64:67], v[72:87]
    s_setprio 0
    v_exp_f32 v42, v42
    v_exp_f32 v43, v43
    v_exp_f32 v44, v44
    v_exp_f32 v45, v45
    v_exp_f32 v46, v46
    v_exp_f32 v47, v47
    v_cvt_pk_bf16_f32 v68, v40, v41
    v_cvt_pk_bf16_f32 v69, v42, v43
    v_cvt_pk_bf16_f32 v70, v44, v45
    v_cvt_pk_bf16_f32 v71, v46, v47
    v_exp_f32 v48, v48
    v_exp_f32 v49, v49
    v_mfma_f32_32x32x16_bf16 v[72:87], v[20:23], v[68:71], v[72:87]
    s_mov_b64 exec, s[56:57]
    ds_read_b128 v[16:19], v89 offset:59392
    ds_read_b128 v[20:23], v89 offset:59904
    s_mov_b64 exec, -1
    ds_read_b128 v[12:15], v88 offset:60416
    v_exp_f32 v50, v50
    v_exp_f32 v51, v51
    v_exp_f32 v52, v52
    v_exp_f32 v53, v53
    s_waitcnt lgkmcnt(3)
    v_mfma_f32_32x32x16_bf16 v[32:47], v[8:11], v[4:7], 0
    s_setprio 1
    v_exp_f32 v54, v54
    v_exp_f32 v55, v55
    v_cvt_pk_bf16_f32 v64, v48, v49
    v_cvt_pk_bf16_f32 v65, v50, v51
    v_cvt_pk_bf16_f32 v66, v52, v53
    v_cvt_pk_bf16_f32 v67, v54, v55
    v_exp_f32 v56, v56
    v_exp_f32 v57, v57
    v_mfma_f32_32x32x16_bf16 v[72:87], v[24:27], v[64:67], v[72:87]
    s_setprio 0
    v_exp_f32 v58, v58
    v_exp_f32 v59, v59
    v_exp_f32 v60, v60
    v_exp_f32 v61, v61
    v_exp_f32 v62, v62
    v_exp_f32 v63, v63
    v_cvt_pk_bf16_f32 v68, v56, v57
    v_cvt_pk_bf16_f32 v69, v58, v59
    v_cvt_pk_bf16_f32 v70, v60, v61
    v_cvt_pk_bf16_f32 v71, v62, v63
    v_exp_f32 v32, v32
    v_exp_f32 v33, v33
    v_mfma_f32_32x32x16_bf16 v[72:87], v[28:31], v[68:71], v[72:87]
    s_mov_b64 exec, s[56:57]
    ds_read_b128 v[24:27], v89 offset:60416
    ds_read_b128 v[28:31], v89 offset:60928
    s_mov_b64 exec, -1
    ds_read_b128 v[8:11], v88 offset:61440
    v_exp_f32 v34, v34
    v_exp_f32 v35, v35
    v_exp_f32 v36, v36
    v_exp_f32 v37, v37
    s_waitcnt lgkmcnt(3)
    v_mfma_f32_32x32x16_bf16 v[48:63], v[12:15], v[4:7], 0
    s_setprio 1
    v_exp_f32 v38, v38
    v_exp_f32 v39, v39
    v_cvt_pk_bf16_f32 v64, v32, v33
    v_cvt_pk_bf16_f32 v65, v34, v35
    v_cvt_pk_bf16_f32 v66, v36, v37
    v_cvt_pk_bf16_f32 v67, v38, v39
    v_exp_f32 v40, v40
    v_exp_f32 v41, v41
    v_mfma_f32_32x32x16_bf16 v[72:87], v[16:19], v[64:67], v[72:87]
    s_setprio 0
    v_exp_f32 v42, v42
    v_exp_f32 v43, v43
    v_exp_f32 v44, v44
    v_exp_f32 v45, v45
    v_exp_f32 v46, v46
    v_exp_f32 v47, v47
    v_cvt_pk_bf16_f32 v68, v40, v41
    v_cvt_pk_bf16_f32 v69, v42, v43
    v_cvt_pk_bf16_f32 v70, v44, v45
    v_cvt_pk_bf16_f32 v71, v46, v47
    v_exp_f32 v48, v48
    v_exp_f32 v49, v49
    v_mfma_f32_32x32x16_bf16 v[72:87], v[20:23], v[68:71], v[72:87]
    s_mov_b64 exec, s[56:57]
    ds_read_b128 v[16:19], v89 offset:61440
    ds_read_b128 v[20:23], v89 offset:61952
    s_mov_b64 exec, -1
    ds_read_b128 v[12:15], v88 offset:62464
    v_exp_f32 v50, v50
    v_exp_f32 v51, v51
    v_exp_f32 v52, v52
    v_exp_f32 v53, v53
    s_waitcnt lgkmcnt(3)
    v_mfma_f32_32x32x16_bf16 v[32:47], v[8:11], v[4:7], 0
    s_setprio 1
    v_exp_f32 v54, v54
    v_exp_f32 v55, v55
    v_cvt_pk_bf16_f32 v64, v48, v49
    v_cvt_pk_bf16_f32 v65, v50, v51
    v_cvt_pk_bf16_f32 v66, v52, v53
    v_cvt_pk_bf16_f32 v67, v54, v55
    v_exp_f32 v56, v56
    v_exp_f32 v57, v57
    v_mfma_f32_32x32x16_bf16 v[72:87], v[24:27], v[64:67], v[72:87]
    s_setprio 0
    v_exp_f32 v58, v58
    v_exp_f32 v59, v59
    v_exp_f32 v60, v60
    v_exp_f32 v61, v61
    v_exp_f32 v62, v62
    v_exp_f32 v63, v63
    v_cvt_pk_bf16_f32 v68, v56, v57
    v_cvt_pk_bf16_f32 v69, v58, v59
    v_cvt_pk_bf16_f32 v70, v60, v61
    v_cvt_pk_bf16_f32 v71, v62, v63
    v_exp_f32 v32, v32
    v_exp_f32 v33, v33
    v_mfma_f32_32x32x16_bf16 v[72:87], v[28:31], v[68:71], v[72:87]
    s_mov_b64 exec, s[56:57]
    ds_read_b128 v[24:27], v89 offset:62464
    ds_read_b128 v[28:31], v89 offset:62976
    s_mov_b64 exec, -1
    ds_read_b128 v[8:11], v88 offset:63488
    v_exp_f32 v34, v34
    v_exp_f32 v35, v35
    v_exp_f32 v36, v36
    v_exp_f32 v37, v37
    s_waitcnt lgkmcnt(3)
    v_mfma_f32_32x32x16_bf16 v[48:63], v[12:15], v[4:7], 0
    s_setprio 1
    v_exp_f32 v38, v38
    v_exp_f32 v39, v39
    v_cvt_pk_bf16_f32 v64, v32, v33
    v_cvt_pk_bf16_f32 v65, v34, v35
    v_cvt_pk_bf16_f32 v66, v36, v37
    v_cvt_pk_bf16_f32 v67, v38, v39
    v_exp_f32 v40, v40
    v_exp_f32 v41, v41
    v_mfma_f32_32x32x16_bf16 v[72:87], v[16:19], v[64:67], v[72:87]
    s_setprio 0
    v_exp_f32 v42, v42
    v_exp_f32 v43, v43
    v_exp_f32 v44, v44
    v_exp_f32 v45, v45
    v_exp_f32 v46, v46
    v_exp_f32 v47, v47
    v_cvt_pk_bf16_f32 v68, v40, v41
    v_cvt_pk_bf16_f32 v69, v42, v43
    v_cvt_pk_bf16_f32 v70, v44, v45
    v_cvt_pk_bf16_f32 v71, v46, v47
    v_exp_f32 v48, v48
    v_exp_f32 v49, v49
    v_mfma_f32_32x32x16_bf16 v[72:87], v[20:23], v[68:71], v[72:87]
    s_mov_b64 exec, s[56:57]
    ds_read_b128 v[16:19], v89 offset:63488
    ds_read_b128 v[20:23], v89 offset:64000
    s_mov_b64 exec, -1
    ds_read_b128 v[12:15], v88 offset:64512
    v_exp_f32 v50, v50
    v_exp_f32 v51, v51
    v_exp_f32 v52, v52
    v_exp_f32 v53, v53
    s_waitcnt lgkmcnt(3)
    v_mfma_f32_32x32x16_bf16 v[32:47], v[8:11], v[4:7], 0
    s_setprio 1
    v_exp_f32 v54, v54
    v_exp_f32 v55, v55
    v_cvt_pk_bf16_f32 v64, v48, v49
    v_cvt_pk_bf16_f32 v65, v50, v51
    v_cvt_pk_bf16_f32 v66, v52, v53
    v_cvt_pk_bf16_f32 v67, v54, v55
    v_exp_f32 v56, v56
    v_exp_f32 v57, v57
    v_mfma_f32_32x32x16_bf16 v[72:87], v[24:27], v[64:67], v[72:87]
    s_setprio 0
    v_exp_f32 v58, v58
    v_exp_f32 v59, v59
    v_exp_f32 v60, v60
    v_exp_f32 v61, v61
    v_exp_f32 v62, v62
    v_exp_f32 v63, v63
    v_cvt_pk_bf16_f32 v68, v56, v57
    v_cvt_pk_bf16_f32 v69, v58, v59
    v_cvt_pk_bf16_f32 v70, v60, v61
    v_cvt_pk_bf16_f32 v71, v62, v63
    v_exp_f32 v32, v32
    v_exp_f32 v33, v33
    v_mfma_f32_32x32x16_bf16 v[72:87], v[28:31], v[68:71], v[72:87]
    s_mov_b64 exec, s[56:57]
    ds_read_b128 v[24:27], v89 offset:64512
    ds_read_b128 v[28:31], v89 offset:65024
    s_mov_b64 exec, -1
    ds_read_b128 v[8:11], v88 offset:64512
    v_exp_f32 v34, v34
    v_exp_f32 v35, v35
    v_exp_f32 v36, v36
    v_exp_f32 v37, v37
    s_waitcnt lgkmcnt(3)
    v_mfma_f32_32x32x16_bf16 v[48:63], v[12:15], v[4:7], 0
    s_setprio 1
    v_exp_f32 v38, v38
    v_exp_f32 v39, v39
    v_cvt_pk_bf16_f32 v64, v32, v33
    v_cvt_pk_bf16_f32 v65, v34, v35
    v_cvt_pk_bf16_f32 v66, v36, v37
    v_cvt_pk_bf16_f32 v67, v38, v39
    v_exp_f32 v40, v40
    v_exp_f32 v41, v41
    v_mfma_f32_32x32x16_bf16 v[72:87], v[16:19], v[64:67], v[72:87]
    s_setprio 0
    v_exp_f32 v42, v42
    v_exp_f32 v43, v43
    v_exp_f32 v44, v44
    v_exp_f32 v45, v45
    v_exp_f32 v46, v46
    v_exp_f32 v47, v47
    v_cvt_pk_bf16_f32 v68, v40, v41
    v_cvt_pk_bf16_f32 v69, v42, v43
    v_cvt_pk_bf16_f32 v70, v44, v45
    v_cvt_pk_bf16_f32 v71, v46, v47
    s_waitcnt vmcnt(0)
    ds_read_b64_tr_b16 v[240:241], v93 offset:0
    ds_read_b64_tr_b16 v[242:243], v93 offset:1024
    ds_read_b64_tr_b16 v[244:245], v94 offset:0
    ds_read_b64_tr_b16 v[246:247], v94 offset:1024
    ds_read_b64_tr_b16 v[248:249], v93 offset:2048
    ds_read_b64_tr_b16 v[250:251], v93 offset:3072
    ds_read_b64_tr_b16 v[252:253], v94 offset:2048
    ds_read_b64_tr_b16 v[254:255], v94 offset:3072
    v_exp_f32 v48, v48
    v_exp_f32 v49, v49
    v_mfma_f32_32x32x16_bf16 v[72:87], v[20:23], v[68:71], v[72:87]
    s_mov_b64 exec, s[56:57]
    ds_read_b128 v[16:19], v89 offset:64512
    ds_read_b128 v[20:23], v89 offset:65024
    s_mov_b64 exec, -1
    ds_read_b128 v[12:15], v88 offset:64512
    v_exp_f32 v50, v50
    v_exp_f32 v51, v51
    v_exp_f32 v52, v52
    v_exp_f32 v53, v53
    s_waitcnt lgkmcnt(3)
    v_mfma_f32_32x32x16_bf16 v[32:47], v[8:11], v[4:7], 0
    s_setprio 1
    v_exp_f32 v54, v54
    v_exp_f32 v55, v55
    v_cvt_pk_bf16_f32 v64, v48, v49
    v_cvt_pk_bf16_f32 v65, v50, v51
    v_cvt_pk_bf16_f32 v66, v52, v53
    v_cvt_pk_bf16_f32 v67, v54, v55
    v_exp_f32 v56, v56
    v_exp_f32 v57, v57
    v_mfma_f32_32x32x16_bf16 v[72:87], v[24:27], v[64:67], v[72:87]
    s_setprio 0
    v_exp_f32 v58, v58
    v_exp_f32 v59, v59
    v_exp_f32 v60, v60
    v_exp_f32 v61, v61
    v_exp_f32 v62, v62
    v_exp_f32 v63, v63
    v_cvt_pk_bf16_f32 v68, v56, v57
    v_cvt_pk_bf16_f32 v69, v58, v59
    v_cvt_pk_bf16_f32 v70, v60, v61
    v_cvt_pk_bf16_f32 v71, v62, v63
    s_nop 1
    v_mfma_f32_32x32x16_bf16 v[72:87], v[28:31], v[68:71], v[72:87]
    s_waitcnt lgkmcnt(0)
    s_nop 7
    s_nop 3
    v_mov_b32 v2, 0
    v_fmac_f32 v2, 0, v72
    v_fmac_f32 v2, 0, v73
    v_fmac_f32 v2, 0, v74
    v_fmac_f32 v2, 0, v75
    v_fmac_f32 v2, 0, v76
    v_fmac_f32 v2, 0, v77
    v_fmac_f32 v2, 0, v78
    v_fmac_f32 v2, 0, v79
    v_cmp_u_f32 s[58:59], v2, v2
    s_mov_b32 s62, 0x5d800000
    v_cmp_nge_f32 s[60:61], s62, v80
    s_mov_b32 s62, 0x21800000
    v_cmp_nle_f32 s[64:65], s62, v80
    s_nop 3
    s_or_b64 s[58:59], s[58:59], s[60:61]
    s_or_b64 s[58:59], s[58:59], s[64:65]
    s_mov_b32 s55, 0
    s_cmp_eq_u64 s[58:59], 0
    s_cbranch_scc0 L_p2_rare_17
L_p2_done_14:
    v_rcp_f32 v2, v80
    s_nop 0
    v_mul_f32 v72, v72, v2
    v_mul_f32 v73, v73, v2
    v_mul_f32 v74, v74, v2
    v_mul_f32 v75, v75, v2
    v_mul_f32 v76, v76, v2
    v_mul_f32 v77, v77, v2
    v_mul_f32 v78, v78, v2
    v_mul_f32 v79, v79, v2
    v_cvt_pk_bf16_f32 v64, v72, v73
    v_cvt_pk_bf16_f32 v65, v74, v75
    v_cvt_pk_bf16_f32 v66, v76, v77
    v_cvt_pk_bf16_f32 v67, v78, v79
    v_min_u32 v64, 0xfffffffe, v64
    s_lshl_b32 s47, s27, 3
    s_add_u32 s47, s47, s3
    s_lshl_b32 s47, s47, 5
    s_add_u32 s47, s47, s26
    s_lshl_b32 s47, s47, 10
    s_add_u32 s47, s47, 6291456
    buffer_store_dwordx4 v[64:67], v1, s[36:39], s47 offen sc1
L_p3_code:
    s_cmp_lg_u32 s3, 0
    s_cbranch_scc1 L_lck_18
    v_cmp_gt_u32 vcc, 32, v113
    s_cbranch_vccz L_lck_18
    s_mov_b32 s61, 0
    s_mov_b32 s60, 14944256
L_lcp_19:
    buffer_load_dword v113, v112, s[68:71], s60 offen sc1
    s_add_u32 s61, s61, 1
    s_waitcnt vmcnt(0)
    v_cmp_gt_u32 vcc, 32, v113
    s_cbranch_vccz L_lck_18
    s_cmp_lt_u32 s61, 0x200000
    s_cbranch_scc1 L_lcp_19
L_lck_18:
    s_barrier
    s_and_b32 s46, s2, 7
    s_lshr_b32 s47, s2, 3
    s_lshl_b32 s48, s46, 2
    s_lshr_b32 s49, s47, 3
    s_add_u32 s26, s48, s49
    s_and_b32 s27, s47, 7
    s_and_b32 s44, s3, 1
    s_lshr_b32 s45, s3, 1
    s_mov_b32 s28, s8
    s_mov_b32 s29, s9
    s_mov_b32 s30, 0x80000
    s_mov_b32 s31, 0x20000
    s_mov_b32 s36, s24
    s_mov_b32 s37, s25
    s_mov_b32 s38, 0x1000000
    s_mov_b32 s39, 0x20000
    s_mov_b32 s32, s4
    s_mov_b32 s33, s5
    s_mov_b32 s34, 0x200000
    s_mov_b32 s35, 0x20000
    s_lshl_b32 s46, s26, 1
    s_add_u32 s58, s46, s44
    s_lshl_b32 s46, s58, 5
    s_lshl_b32 s47, s45, 3
    s_add_u32 s46, s46, s47
    s_lshl_b32 s46, s46, 10
    s_add_u32 s50, s46, 6291456
    s_add_u32 s51, s50, 4096
    buffer_load_dwordx4 v[8:11], v1, s[36:39], s50 offen offset:0 sc1
    buffer_load_dwordx4 v[12:15], v1, s[36:39], s50 offen offset:1024 sc1
    buffer_load_dwordx4 v[16:19], v1, s[36:39], s50 offen offset:2048 sc1
    buffer_load_dwordx4 v[20:23], v1, s[36:39], s50 offen offset:3072 sc1
    buffer_load_dwordx4 v[24:27], v1, s[36:39], s51 offen offset:0 sc1
    buffer_load_dwordx4 v[28:31], v1, s[36:39], s51 offen offset:1024 sc1
    buffer_load_dwordx4 v[32:35], v1, s[36:39], s51 offen offset:2048 sc1
    buffer_load_dwordx4 v[36:39], v1, s[36:39], s51 offen offset:3072 sc1
    v_and_b32 v3, 31, v0
    s_lshl_b32 s46, s58, 5
    v_add_u32 v3, s46, v3
    v_lshlrev_b32 v3, 10, v3
    v_lshrrev_b32 v46, 5, v0
    v_lshlrev_b32 v46, 3, v46
    v_add_u32 v3, v3, v46
    s_lshl_b32 s46, s27, 7
    s_lshl_b32 s47, s45, 5
    s_add_u32 s46, s46, s47
    buffer_load_dwordx2 v[40:41], v3, s[32:35], s46 offen
    buffer_load_dwordx2 v[42:43], v3, s[32:35], s46 offen offset:16
    v_lshrrev_b32 v46, 5, v0
    v_lshlrev_b32 v46, 2, v46
    v_bfe_u32 v47, v0, 2, 2
    v_add_u32 v46, v46, v47
    v_lshlrev_b32 v44, 7, v46
    v_bfe_u32 v46, v0, 4, 1
    v_lshlrev_b32 v46, 1, v46
    v_bfe_u32 v47, v0, 1, 1
    v_add_u32 v46, v46, v47
    v_bfe_u32 v47, v0, 3, 1
    v_lshlrev_b32 v47, 2, v47
    v_xor_b32 v46, v46, v47
    v_lshlrev_b32 v46, 4, v46
    v_add_u32 v44, v44, v46
    v_and_b32 v46, 1, v0
    v_lshlrev_b32 v46, 3, v46
    v_add_u32 v44, v44, v46
    s_and_b32 s46, s45, 1
    s_lshl_b32 s46, s46, 14
    s_lshr_b32 s47, s45, 1
    s_lshl_b32 s47, s47, 16
    s_add_u32 s46, s46, s47
    v_add_u32 v44, s46, v44
    v_xor_b32 v45, 64, v44
    v_mov_b32 v64, 0
    v_mov_b32 v65, 0
    v_mov_b32 v66, 0
    v_mov_b32 v67, 0
    v_mov_b32 v68, 0
    v_mov_b32 v69, 0
    v_mov_b32 v70, 0
    v_mov_b32 v71, 0
    v_mov_b32 v72, 0
    v_mov_b32 v73, 0
    v_mov_b32 v74, 0
    v_mov_b32 v75, 0
    v_mov_b32 v76, 0
    v_mov_b32 v77, 0
    v_mov_b32 v78, 0
    v_mov_b32 v79, 0
    v_mov_b32 v80, 0
    v_mov_b32 v81, 0
    v_mov_b32 v82, 0
    v_mov_b32 v83, 0
    v_mov_b32 v84, 0
    v_mov_b32 v85, 0
    v_mov_b32 v86, 0
    v_mov_b32 v87, 0
    v_mov_b32 v88, 0
    v_mov_b32 v89, 0
    v_mov_b32 v90, 0
    v_mov_b32 v91, 0
    v_mov_b32 v92, 0
    v_mov_b32 v93, 0
    v_mov_b32 v94, 0
    v_mov_b32 v95, 0
    s_waitcnt lgkmcnt(0)
    s_barrier
    s_mov_b32 s28, s16
    s_mov_b32 s29, s17
    s_mov_b32 s30, 0x700000
    s_mov_b32 s31, 0x20000
    v_lshrrev_b32 v2, 3, v0
    s_mov_b32 s65, 4096
    v_mul_lo_u32 v60, v2, s65
    v_bfe_u32 v2, v0, 4, 1
    v_lshlrev_b32 v2, 2, v2
    v_and_b32 v3, 7, v0
    v_xor_b32 v2, v2, v3
    v_lshlrev_b32 v2, 4, v2
    v_add_u32 v60, v60, v2
    s_and_b32 s60, s2, 7
    s_lshr_b32 s61, s2, 3
    s_lshl_b32 s60, s60, 2
    s_lshr_b32 s61, s61, 3
    s_add_u32 s60, s60, s61
    s_lshl_b32 s60, s60, 7
    s_mul_i32 s61, s3, 917504
    s_add_u32 s60, s60, s61
    v_add_u32 v60, s60, v60
    s_lshl_b32 s59, s3, 13
    s_add_u32 s59, s59, 98304
    s_lshl_b32 s55, s3, 11
    s_add_u32 s55, s55, 49152
    s_and_b32 s60, s3, 3
    s_lshl_b32 s60, s60, 13
    s_lshr_b32 s61, s3, 2
    s_lshl_b32 s61, s61, 16
    s_add_u32 s57, s60, s61
    v_lshrrev_b32 v2, 5, v0
    v_lshlrev_b32 v2, 2, v2
    v_bfe_u32 v3, v0, 2, 2
    v_add_u32 v2, v2, v3
    v_lshlrev_b32 v61, 7, v2
    v_bfe_u32 v2, v0, 4, 1
    v_lshlrev_b32 v2, 1, v2
    v_bfe_u32 v3, v0, 1, 1
    v_add_u32 v2, v2, v3
    v_bfe_u32 v3, v0, 3, 1
    v_lshlrev_b32 v3, 2, v3
    v_xor_b32 v2, v2, v3
    v_lshlrev_b32 v2, 4, v2
    v_add_u32 v61, v61, v2
    v_and_b32 v2, 1, v0
    v_lshlrev_b32 v2, 3, v2
    v_add_u32 v61, v61, v2
    v_xor_b32 v62, 64, v61
    ds_read_b64_tr_b16 v[96:97], v44 offset:0
    ds_read_b64_tr_b16 v[98:99], v44 offset:1024
    ds_read_b64_tr_b16 v[100:101], v45 offset:0
    ds_read_b64_tr_b16 v[102:103], v45 offset:1024
    ds_read_b64_tr_b16 v[104:105], v44 offset:2048
    ds_read_b64_tr_b16 v[106:107], v44 offset:3072
    ds_read_b64_tr_b16 v[108:109], v45 offset:2048
    ds_read_b64_tr_b16 v[110:111], v45 offset:3072
    ds_read_b64_tr_b16 v[112:113], v44 offset:4096
    ds_read_b64_tr_b16 v[114:115], v44 offset:5120
    ds_read_b64_tr_b16 v[116:117], v45 offset:4096
    ds_read_b64_tr_b16 v[118:119], v45 offset:5120
    s_mov_b32 m0, s59
    s_mov_b32 s60, 0
    buffer_load_dwordx4 v60, s[28:31], s60 offen lds
    s_add_u32 m0, s59, 1024
    s_mov_b32 s60, 32768
    buffer_load_dwordx4 v60, s[28:31], s60 offen lds
    s_add_u32 m0, s59, 2048
    s_mov_b32 s60, 65536
    buffer_load_dwordx4 v60, s[28:31], s60 offen lds
    s_add_u32 m0, s59, 3072
    s_mov_b32 s60, 98304
    buffer_load_dwordx4 v60, s[28:31], s60 offen lds
    s_add_u32 m0, s59, 4096
    s_mov_b32 s60, 131072
    buffer_load_dwordx4 v60, s[28:31], s60 offen lds
    s_add_u32 m0, s59, 5120
    s_mov_b32 s60, 163840
    buffer_load_dwordx4 v60, s[28:31], s60 offen lds
    s_add_u32 m0, s59, 6144
    s_mov_b32 s60, 196608
    buffer_load_dwordx4 v60, s[28:31], s60 offen lds
    s_add_u32 m0, s59, 7168
    s_mov_b32 s60, 229376
    buffer_load_dwordx4 v60, s[28:31], s60 offen lds
    s_mov_b32 m0, s55
    s_mov_b32 s60, 262144
    buffer_load_dwordx4 v60, s[28:31], s60 offen lds
    s_add_u32 m0, s55, 1024
    s_mov_b32 s60, 294912
    buffer_load_dwordx4 v60, s[28:31], s60 offen lds
    s_waitcnt vmcnt(19)
    v_cmp_eq_u32 vcc, -1, v8
    s_cbranch_vccnz L_os_r_23
L_os_b_24:
    ds_read_b64_tr_b16 v[120:121], v44 offset:6144
    ds_read_b64_tr_b16 v[122:123], v44 offset:7168
    ds_read_b64_tr_b16 v[124:125], v45 offset:6144
    ds_read_b64_tr_b16 v[126:127], v45 offset:7168
    s_waitcnt lgkmcnt(12)
    v_mfma_f32_32x32x16_bf16 v[64:79], v[96:99], v[8:11], v[64:79]
    v_mfma_f32_32x32x16_bf16 v[80:95], v[100:103], v[8:11], v[80:95]
    s_waitcnt vmcnt(18)
    v_cmp_eq_u32 vcc, -1, v12
    s_cbranch_vccnz L_os_r_25
L_os_b_26:
    ds_read_b64_tr_b16 v[96:97], v44 offset:8192
    ds_read_b64_tr_b16 v[98:99], v44 offset:9216
    ds_read_b64_tr_b16 v[100:101], v45 offset:8192
    ds_read_b64_tr_b16 v[102:103], v45 offset:9216
    s_waitcnt lgkmcnt(12)
    v_mfma_f32_32x32x16_bf16 v[64:79], v[104:107], v[12:15], v[64:79]
    v_mfma_f32_32x32x16_bf16 v[80:95], v[108:111], v[12:15], v[80:95]
    s_waitcnt vmcnt(17)
    v_cmp_eq_u32 vcc, -1, v16
    s_cbranch_vccnz L_os_r_27
L_os_b_28:
    ds_read_b64_tr_b16 v[104:105], v44 offset:10240
    ds_read_b64_tr_b16 v[106:107], v44 offset:11264
    ds_read_b64_tr_b16 v[108:109], v45 offset:10240
    ds_read_b64_tr_b16 v[110:111], v45 offset:11264
    s_waitcnt lgkmcnt(12)
    v_mfma_f32_32x32x16_bf16 v[64:79], v[112:115], v[16:19], v[64:79]
    v_mfma_f32_32x32x16_bf16 v[80:95], v[116:119], v[16:19], v[80:95]
    s_waitcnt vmcnt(16)
    v_cmp_eq_u32 vcc, -1, v20
    s_cbranch_vccnz L_os_r_29
L_os_b_30:
    ds_read_b64_tr_b16 v[112:113], v44 offset:12288
    ds_read_b64_tr_b16 v[114:115], v44 offset:13312
    ds_read_b64_tr_b16 v[116:117], v45 offset:12288
    ds_read_b64_tr_b16 v[118:119], v45 offset:13312
    s_waitcnt lgkmcnt(12)
    v_mfma_f32_32x32x16_bf16 v[64:79], v[120:123], v[20:23], v[64:79]
    v_mfma_f32_32x32x16_bf16 v[80:95], v[124:127], v[20:23], v[80:95]
    s_waitcnt vmcnt(15)
    v_cmp_eq_u32 vcc, -1, v24
    s_cbranch_vccnz L_os_r_31
L_os_b_32:
    ds_read_b64_tr_b16 v[120:121], v44 offset:14336
    ds_read_b64_tr_b16 v[122:123], v44 offset:15360
    ds_read_b64_tr_b16 v[124:125], v45 offset:14336
    ds_read_b64_tr_b16 v[126:127], v45 offset:15360
    s_waitcnt lgkmcnt(12)
    v_mfma_f32_32x32x16_bf16 v[64:79], v[96:99], v[24:27], v[64:79]
    v_mfma_f32_32x32x16_bf16 v[80:95], v[100:103], v[24:27], v[80:95]
    s_waitcnt vmcnt(14)
    v_cmp_eq_u32 vcc, -1, v28
    s_cbranch_vccnz L_os_r_33
L_os_b_34:
    s_waitcnt lgkmcnt(8)
    v_mfma_f32_32x32x16_bf16 v[64:79], v[104:107], v[28:31], v[64:79]
    v_mfma_f32_32x32x16_bf16 v[80:95], v[108:111], v[28:31], v[80:95]
    s_waitcnt vmcnt(13)
    v_cmp_eq_u32 vcc, -1, v32
    s_cbranch_vccnz L_os_r_35
L_os_b_36:
    s_waitcnt lgkmcnt(4)
    v_mfma_f32_32x32x16_bf16 v[64:79], v[112:115], v[32:35], v[64:79]
    v_mfma_f32_32x32x16_bf16 v[80:95], v[116:119], v[32:35], v[80:95]
    s_waitcnt vmcnt(12)
    v_cmp_eq_u32 vcc, -1, v36
    s_cbranch_vccnz L_os_r_37
L_os_b_38:
    s_waitcnt lgkmcnt(0)
    v_mfma_f32_32x32x16_bf16 v[64:79], v[120:123], v[36:39], v[64:79]
    v_mfma_f32_32x32x16_bf16 v[80:95], v[124:127], v[36:39], v[80:95]
    s_waitcnt vmcnt(10)
    s_nop 7
    s_nop 3
    s_barrier
    s_lshl_b32 s46, s44, 16
    s_lshl_b32 s47, s45, 11
    s_add_u32 s47, s47, s46
    s_add_u32 s47, s47, 0
    v_lshlrev_b32 v46, 4, v0
    v_add_u32 v47, s47, v46
    ds_write_b128 v47, v[64:67] offset:0
    ds_write_b128 v47, v[68:71] offset:1024
    ds_write_b128 v47, v[72:75] offset:8192
    ds_write_b128 v47, v[76:79] offset:9216
    ds_write_b128 v47, v[80:83] offset:16384
    ds_write_b128 v47, v[84:87] offset:17408
    ds_write_b128 v47, v[88:91] offset:24576
    ds_write_b128 v47, v[92:95] offset:25600
    s_lshl_b32 s47, s45, 13
    s_add_u32 s47, s47, s46
    s_add_u32 s47, s47, 0
    v_add_u32 v47, s47, v46
    s_waitcnt lgkmcnt(0)
    s_barrier
    ds_read_b128 v[8:11], v47 offset:0
    ds_read_b128 v[12:15], v47 offset:1024
    ds_read_b128 v[16:19], v47 offset:2048
    ds_read_b128 v[20:23], v47 offset:3072
    ds_read_b128 v[24:27], v47 offset:4096
    ds_read_b128 v[28:31], v47 offset:5120
    ds_read_b128 v[32:35], v47 offset:6144
    ds_read_b128 v[36:39], v47 offset:7168
    s_waitcnt lgkmcnt(4)
    v_add_f32 v64, v8, v16
    v_add_f32 v65, v9, v17
    v_add_f32 v66, v10, v18
    v_add_f32 v67, v11, v19
    v_add_f32 v68, v12, v20
    v_add_f32 v69, v13, v21
    v_add_f32 v70, v14, v22
    v_add_f32 v71, v15, v23
    s_waitcnt lgkmcnt(0)
    v_add_f32 v24, v24, v32
    v_add_f32 v25, v25, v33
    v_add_f32 v26, v26, v34
    v_add_f32 v27, v27, v35
    v_add_f32 v28, v28, v36
    v_add_f32 v29, v29, v37
    v_add_f32 v30, v30, v38
    v_add_f32 v31, v31, v39
    v_add_f32 v64, v64, v24
    v_add_f32 v65, v65, v25
    v_add_f32 v66, v66, v26
    v_add_f32 v67, v67, v27
    v_add_f32 v68, v68, v28
    v_add_f32 v69, v69, v29
    v_add_f32 v70, v70, v30
    v_add_f32 v71, v71, v31
    v_lshlrev_b32 v8, 16, v40
    v_and_b32 v9, 0xffff0000, v40
    v_lshlrev_b32 v10, 16, v41
    v_and_b32 v11, 0xffff0000, v41
    v_lshlrev_b32 v12, 16, v42
    v_and_b32 v13, 0xffff0000, v42
    v_lshlrev_b32 v14, 16, v43
    v_and_b32 v15, 0xffff0000, v43
    v_add_f32 v8, v8, v64
    v_add_f32 v9, v9, v65
    v_add_f32 v10, v10, v66
    v_add_f32 v11, v11, v67
    v_add_f32 v12, v12, v68
    v_add_f32 v13, v13, v69
    v_add_f32 v14, v14, v70
    v_add_f32 v15, v15, v71
    v_cvt_pk_bf16_f32 v4, v8, v9
    v_cvt_pk_bf16_f32 v5, v10, v11
    v_cvt_pk_bf16_f32 v6, v12, v13
    v_cvt_pk_bf16_f32 v7, v14, v15
    v_lshlrev_b32 v8, 16, v4
    v_and_b32 v9, 0xffff0000, v4
    v_lshlrev_b32 v10, 16, v5
    v_and_b32 v11, 0xffff0000, v5
    v_lshlrev_b32 v12, 16, v6
    v_and_b32 v13, 0xffff0000, v6
    v_lshlrev_b32 v14, 16, v7
    v_and_b32 v15, 0xffff0000, v7
    v_add_f32 v20, v8, v9
    v_mul_f32 v21, v8, v8
    v_fmac_f32 v21, v9, v9
    v_add_f32 v20, v20, v10
    v_fmac_f32 v21, v10, v10
    v_add_f32 v20, v20, v11
    v_fmac_f32 v21, v11, v11
    v_add_f32 v20, v20, v12
    v_fmac_f32 v21, v12, v12
    v_add_f32 v20, v20, v13
    v_fmac_f32 v21, v13, v13
    v_add_f32 v20, v20, v14
    v_fmac_f32 v21, v14, v14
    v_add_f32 v20, v20, v15
    v_fmac_f32 v21, v15, v15
    v_mov_b32 v22, v20
    v_mov_b32 v23, v21
    s_nop 1
    v_permlane32_swap_b32 v20, v22
    v_permlane32_swap_b32 v21, v23
    s_nop 1
    v_add_f32 v20, v20, v22
    v_add_f32 v21, v21, v23
    v_and_b32 v46, 31, v0
    s_lshl_b32 s46, s44, 5
    v_add_u32 v46, s46, v46
    v_lshlrev_b32 v24, 3, v46
    s_lshl_b32 s46, s45, 9
    s_add_u32 s46, s46, 32768
    v_add_u32 v47, s46, v24
    v_cmp_gt_u32 vcc, 32, v0
    s_and_saveexec_b64 s[52:53], vcc
    ds_write_b64 v47, v[20:21]
    s_mov_b64 exec, s[52:53]
    s_waitcnt lgkmcnt(0)
    s_barrier
    s_lshl_b32 s46, s26, 12
    s_add_u32 s46, s46, 14680064
    s_lshl_b32 s47, s27, 9
    s_add_u32 s47, s47, s46
    v_lshlrev_b32 v48, 3, v0
    s_cmp_eq_u32 s3, 0
    s_cbranch_scc1 L_p3_x0_40
    s_cmp_lg_u32 s3, 1
    s_cbranch_scc1 L_p3_x1_41
    v_add_u32 v49, 32768, v48
    ds_read_b64 v[26:27], v49 offset:0
    ds_read_b64 v[28:29], v49 offset:512
    ds_read_b64 v[30:31], v49 offset:1024
    ds_read_b64 v[32:33], v49 offset:1536
    s_waitcnt lgkmcnt(0)
    v_add_f32 v26, v26, v28
    v_add_f32 v27, v27, v29
    v_add_f32 v30, v30, v32
    v_add_f32 v31, v31, v33
    v_add_f32 v26, v26, v30
    v_add_f32 v27, v27, v31
    v_min_u32 v26, 0xfffffffe, v26
    v_min_u32 v27, 0xfffffffe, v27
    buffer_store_dwordx2 v[26:27], v48, s[36:39], s47 offen sc1
L_p3_x1_41:
    s_mov_b32 m0, s57
    s_mov_b32 s60, 327680
    buffer_load_dwordx4 v60, s[28:31], s60 offen lds
    s_add_u32 m0, s57, 1024
    s_mov_b32 s60, 360448
    buffer_load_dwordx4 v60, s[28:31], s60 offen lds
    s_add_u32 m0, s57, 2048
    s_mov_b32 s60, 393216
    buffer_load_dwordx4 v60, s[28:31], s60 offen lds
    s_add_u32 m0, s57, 3072
    s_mov_b32 s60, 425984
    buffer_load_dwordx4 v60, s[28:31], s60 offen lds
    s_add_u32 m0, s57, 4096
    s_mov_b32 s60, 458752
    buffer_load_dwordx4 v60, s[28:31], s60 offen lds
    s_add_u32 m0, s57, 5120
    s_mov_b32 s60, 491520
    buffer_load_dwordx4 v60, s[28:31], s60 offen lds
    s_add_u32 m0, s57, 6144
    s_mov_b32 s60, 524288
    buffer_load_dwordx4 v60, s[28:31], s60 offen lds
    s_add_u32 m0, s57, 7168
    s_mov_b32 s60, 557056
    buffer_load_dwordx4 v60, s[28:31], s60 offen lds
    s_branch L_p3_x_39
L_p3_x0_40:
    s_mov_b32 s48, 0
L_p3_poll_42:
    buffer_load_dwordx2 v[32:33], v48, s[36:39], s46 offen offset:0 sc1
    buffer_load_dwordx2 v[34:35], v48, s[36:39], s46 offen offset:512 sc1
    buffer_load_dwordx2 v[36:37], v48, s[36:39], s46 offen offset:1024 sc1
    buffer_load_dwordx2 v[38:39], v48, s[36:39], s46 offen offset:1536 sc1
    buffer_load_dwordx2 v[40:41], v48, s[36:39], s46 offen offset:2048 sc1
    buffer_load_dwordx2 v[42:43], v48, s[36:39], s46 offen offset:2560 sc1
    buffer_load_dwordx2 v[44:45], v48, s[36:39], s46 offen offset:3072 sc1
    buffer_load_dwordx2 v[46:47], v48, s[36:39], s46 offen offset:3584 sc1
    s_waitcnt vmcnt(0)
    v_cmp_eq_u32 vcc, -1, v32
    v_cmp_eq_u32 s[62:63], -1, v33
    s_or_b64 vcc, vcc, s[62:63]
    v_cmp_eq_u32 s[62:63], -1, v34
    s_or_b64 vcc, vcc, s[62:63]
    v_cmp_eq_u32 s[62:63], -1, v35
    s_or_b64 vcc, vcc, s[62:63]
    v_cmp_eq_u32 s[62:63], -1, v36
    s_or_b64 vcc, vcc, s[62:63]
    v_cmp_eq_u32 s[62:63], -1, v37
    s_or_b64 vcc, vcc, s[62:63]
    v_cmp_eq_u32 s[62:63], -1, v38
    s_or_b64 vcc, vcc, s[62:63]
    v_cmp_eq_u32 s[62:63], -1, v39
    s_or_b64 vcc, vcc, s[62:63]
    v_cmp_eq_u32 s[62:63], -1, v40
    s_or_b64 vcc, vcc, s[62:63]
    v_cmp_eq_u32 s[62:63], -1, v41
    s_or_b64 vcc, vcc, s[62:63]
    v_cmp_eq_u32 s[62:63], -1, v42
    s_or_b64 vcc, vcc, s[62:63]
    v_cmp_eq_u32 s[62:63], -1, v43
    s_or_b64 vcc, vcc, s[62:63]
    v_cmp_eq_u32 s[62:63], -1, v44
    s_or_b64 vcc, vcc, s[62:63]
    v_cmp_eq_u32 s[62:63], -1, v45
    s_or_b64 vcc, vcc, s[62:63]
    v_cmp_eq_u32 s[62:63], -1, v46
    s_or_b64 vcc, vcc, s[62:63]
    v_cmp_eq_u32 s[62:63], -1, v47
    s_or_b64 vcc, vcc, s[62:63]
    s_cbranch_vccnz L_p3_r_44
    s_branch L_p3_pd_43
L_p3_r_44:
    s_add_u32 s48, s48, 1
    s_cmp_lt_u32 s48, 0x100000
    s_cbranch_scc1 L_p3_poll_42
L_p3_pd_43:
    v_add_f32 v32, v32, v34
    v_add_f32 v33, v33, v35
    v_add_f32 v32, v32, v36
    v_add_f32 v33, v33, v37
    v_add_f32 v32, v32, v38
    v_add_f32 v33, v33, v39
    v_add_f32 v32, v32, v40
    v_add_f32 v33, v33, v41
    v_add_f32 v32, v32, v42
    v_add_f32 v33, v33, v43
    v_add_f32 v32, v32, v44
    v_add_f32 v33, v33, v45
    v_add_f32 v32, v32, v46
    v_add_f32 v33, v33, v47
    v_mul_f32 v32, 0x3b000000, v32
    v_mul_f32 v33, 0x3b000000, v33
    v_fma_f32 v33, -v32, v32, v33
    v_max_f32 v33, 0, v33
    v_add_f32 v34, 0x3727c5ac, v33
    v_rsq_f32 v35, v34
    s_nop 0
    v_mul_f32 v36, v35, v35
    v_mul_f32 v36, v36, v33
    v_add_f32 v36, 0x3727c5ac, v36
    v_rsq_f32 v36, v36
    s_nop 0
    v_mul_f32 v34, v35, v36
    v_mul_f32 v35, v32, v34
    v_sub_f32 v35, 0, v35
    v_add_u32 v49, 34816, v48
    ds_write_b64 v49, v[34:35]
    s_mov_b32 m0, s57
    s_mov_b32 s60, 327680
    buffer_load_dwordx4 v60, s[28:31], s60 offen lds
    s_add_u32 m0, s57, 1024
    s_mov_b32 s60, 360448
    buffer_load_dwordx4 v60, s[28:31], s60 offen lds
    s_add_u32 m0, s57, 2048
    s_mov_b32 s60, 393216
    buffer_load_dwordx4 v60, s[28:31], s60 offen lds
    s_add_u32 m0, s57, 3072
    s_mov_b32 s60, 425984
    buffer_load_dwordx4 v60, s[28:31], s60 offen lds
    s_add_u32 m0, s57, 4096
    s_mov_b32 s60, 458752
    buffer_load_dwordx4 v60, s[28:31], s60 offen lds
    s_add_u32 m0, s57, 5120
    s_mov_b32 s60, 491520
    buffer_load_dwordx4 v60, s[28:31], s60 offen lds
    s_add_u32 m0, s57, 6144
    s_mov_b32 s60, 524288
    buffer_load_dwordx4 v60, s[28:31], s60 offen lds
    s_add_u32 m0, s57, 7168
    s_mov_b32 s60, 557056
    buffer_load_dwordx4 v60, s[28:31], s60 offen lds
    s_waitcnt lgkmcnt(0)
L_p3_x_39:
    s_barrier
    v_add_u32 v47, 34816, v24
    ds_read_b64 v[20:21], v47
    s_waitcnt lgkmcnt(0)
    v_fma_f32 v8, v8, v20, v21
    v_fma_f32 v9, v9, v20, v21
    v_fma_f32 v10, v10, v20, v21
    v_fma_f32 v11, v11, v20, v21
    v_fma_f32 v12, v12, v20, v21
    v_fma_f32 v13, v13, v20, v21
    v_fma_f32 v14, v14, v20, v21
    v_fma_f32 v15, v15, v20, v21
    v_cvt_pk_bf16_f32 v16, v8, v9
    v_cvt_pk_bf16_f32 v17, v10, v11
    v_cvt_pk_bf16_f32 v18, v12, v13
    v_cvt_pk_bf16_f32 v19, v14, v15
    v_lshrrev_b32 v46, 3, v24
    v_bfe_u32 v47, v46, 1, 1
    v_lshlrev_b32 v47, 2, v47
    s_lshl_b32 s46, s45, 1
    v_xor_b32 v47, s46, v47
    v_lshlrev_b32 v47, 4, v47
    v_lshlrev_b32 v46, 7, v46
    v_add_u32 v46, v46, v47
    v_lshrrev_b32 v47, 5, v0
    v_lshlrev_b32 v47, 3, v47
    v_add_u32 v46, v46, v47
    ds_write_b64 v46, v[16:17] offset:36864
    ds_write_b64 v46, v[18:19] offset:36880
    s_lshl_b32 s46, s44, 2
    v_lshrrev_b32 v46, 5, v0
    v_lshlrev_b32 v46, 2, v46
    v_bfe_u32 v47, v0, 2, 2
    v_add_u32 v46, v46, v47
    v_lshlrev_b32 v48, 7, v46
    v_bfe_u32 v46, v0, 4, 1
    v_lshlrev_b32 v46, 1, v46
    v_bfe_u32 v47, v0, 1, 1
    v_add_u32 v46, v46, v47
    v_add_u32 v46, s46, v46
    v_bfe_u32 v47, v0, 3, 1
    v_lshlrev_b32 v47, 2, v47
    v_xor_b32 v46, v46, v47
    v_lshlrev_b32 v46, 4, v46
    v_add_u32 v48, v48, v46
    v_and_b32 v46, 1, v0
    v_lshlrev_b32 v46, 3, v46
    v_add_u32 v48, v48, v46
    s_lshl_b32 s46, s45, 11
    v_add_u32 v48, s46, v48
    s_waitcnt lgkmcnt(0)
    s_barrier
    ds_read_b64_tr_b16 v[24:25], v48 offset:36864
    ds_read_b64_tr_b16 v[26:27], v48 offset:37888
    s_waitcnt lgkmcnt(0)
    v_min_u32 v24, 0xfffffffe, v24
    buffer_store_dwordx4 v[24:27], v1, s[36:39], s97 offen sc1
    s_and_b32 s46, s2, 7
    s_lshr_b32 s47, s2, 3
    s_and_b32 s48, s46, 1
    s_lshl_b32 s48, s48, 2
    s_and_b32 s49, s47, 3
    s_add_u32 s26, s48, s49
    s_mov_b32 s32, s14
    s_mov_b32 s33, s15
    s_mov_b32 s34, 0xe00
    s_mov_b32 s35, 0x20000
    s_and_b32 s46, s3, 1
    s_lshl_b32 s46, s46, 6
    s_bfe_u32 s47, s3, 0x10001
    s_lshl_b32 s47, s47, 5
    s_add_u32 s46, s46, s47
    s_add_u32 s46, s46, s99
    v_lshrrev_b32 v2, 5, v0
    v_lshlrev_b32 v2, 3, v2
    buffer_load_dwordx2 v[56:57], v2, s[32:35], s46 offen
    buffer_load_dwordx2 v[58:59], v2, s[32:35], s46 offen offset:16
    s_lshl_b32 s46, s26, 18
    s_lshl_b32 s47, s3, 14
    s_add_u32 s46, s46, s47
    s_add_u32 s54, s46, 10485760
    s_add_u32 s56, s46, 10616832
    s_cmp_eq_u32 s100, 0
    s_cbranch_scc1 L_p4_idle_45
    s_waitcnt vmcnt(0)
    s_nop 0
    s_add_u32 s52, s54, 0
    buffer_load_dwordx4 v[8:11], v1, s[36:39], s52 offen sc1
    s_add_u32 s52, s56, 0
    buffer_load_dwordx4 v[12:15], v1, s[36:39], s52 offen sc1
    s_add_u32 s52, s54, 1024
    buffer_load_dwordx4 v[16:19], v1, s[36:39], s52 offen sc1
    s_add_u32 s52, s56, 1024
    buffer_load_dwordx4 v[20:23], v1, s[36:39], s52 offen sc1
    s_add_u32 s52, s54, 2048
    buffer_load_dwordx4 v[24:27], v1, s[36:39], s52 offen sc1
    s_add_u32 s52, s56, 2048
    buffer_load_dwordx4 v[28:31], v1, s[36:39], s52 offen sc1
    s_add_u32 s52, s54, 3072
    buffer_load_dwordx4 v[32:35], v1, s[36:39], s52 offen sc1
    s_add_u32 s52, s56, 3072
    buffer_load_dwordx4 v[36:39], v1, s[36:39], s52 offen sc1
    s_add_u32 s52, s54, 4096
    buffer_load_dwordx4 v[40:43], v1, s[36:39], s52 offen sc1
    s_add_u32 s52, s56, 4096
    buffer_load_dwordx4 v[44:47], v1, s[36:39], s52 offen sc1
    s_add_u32 s52, s54, 5120
    buffer_load_dwordx4 v[48:51], v1, s[36:39], s52 offen sc1
    s_add_u32 s52, s56, 5120
    buffer_load_dwordx4 v[52:55], v1, s[36:39], s52 offen sc1
    v_mov_b32 v64, 0
    v_mov_b32 v65, 0
    v_mov_b32 v66, 0
    v_mov_b32 v67, 0
    v_mov_b32 v68, 0
    v_mov_b32 v69, 0
    v_mov_b32 v70, 0
    v_mov_b32 v71, 0
    v_mov_b32 v72, 0
    v_mov_b32 v73, 0
    v_mov_b32 v74, 0
    v_mov_b32 v75, 0
    v_mov_b32 v76, 0
    v_mov_b32 v77, 0
    v_mov_b32 v78, 0
    v_mov_b32 v79, 0
    v_mov_b32 v80, 0
    v_mov_b32 v81, 0
    v_mov_b32 v82, 0
    v_mov_b32 v83, 0
    v_mov_b32 v84, 0
    v_mov_b32 v85, 0
    v_mov_b32 v86, 0
    v_mov_b32 v87, 0
    v_mov_b32 v88, 0
    v_mov_b32 v89, 0
    v_mov_b32 v90, 0
    v_mov_b32 v91, 0
    v_mov_b32 v92, 0
    v_mov_b32 v93, 0
    v_mov_b32 v94, 0
    v_mov_b32 v95, 0
    v_mov_b32 v96, 0
    v_mov_b32 v97, 0
    v_mov_b32 v98, 0
    v_mov_b32 v99, 0
    v_mov_b32 v100, 0
    v_mov_b32 v101, 0
    v_mov_b32 v102, 0
    v_mov_b32 v103, 0
    v_mov_b32 v104, 0
    v_mov_b32 v105, 0
    v_mov_b32 v106, 0
    v_mov_b32 v107, 0
    v_mov_b32 v108, 0
    v_mov_b32 v109, 0
    v_mov_b32 v110, 0
    v_mov_b32 v111, 0
    v_mov_b32 v112, 0
    v_mov_b32 v113, 0
    v_mov_b32 v114, 0
    v_mov_b32 v115, 0
    v_mov_b32 v116, 0
    v_mov_b32 v117, 0
    v_mov_b32 v118, 0
    v_mov_b32 v119, 0
    v_mov_b32 v120, 0
    v_mov_b32 v121, 0
    v_mov_b32 v122, 0
    v_mov_b32 v123, 0
    v_mov_b32 v124, 0
    v_mov_b32 v125, 0
    v_mov_b32 v126, 0
    v_mov_b32 v127, 0
    s_waitcnt vmcnt(10)
    s_mov_b32 s53, 0
L_i0_49:
    v_cmp_eq_u32 vcc, -1, v8
    v_cmp_eq_u32 s[62:63], -1, v12
    s_or_b64 vcc, vcc, s[62:63]
    s_cbranch_vccz L_i0ok_50
    s_add_u32 s52, s54, 0
    buffer_load_dwordx4 v[8:11], v1, s[36:39], s52 offen sc1
    s_add_u32 s52, s56, 0
    buffer_load_dwordx4 v[12:15], v1, s[36:39], s52 offen sc1
    s_add_u32 s52, s54, 1024
    buffer_load_dwordx4 v[16:19], v1, s[36:39], s52 offen sc1
    s_add_u32 s52, s56, 1024
    buffer_load_dwordx4 v[20:23], v1, s[36:39], s52 offen sc1
    s_add_u32 s52, s54, 2048
    buffer_load_dwordx4 v[24:27], v1, s[36:39], s52 offen sc1
    s_add_u32 s52, s56, 2048
    buffer_load_dwordx4 v[28:31], v1, s[36:39], s52 offen sc1
    s_add_u32 s52, s54, 3072
    buffer_load_dwordx4 v[32:35], v1, s[36:39], s52 offen sc1
    s_add_u32 s52, s56, 3072
    buffer_load_dwordx4 v[36:39], v1, s[36:39], s52 offen sc1
    s_add_u32 s52, s54, 4096
    buffer_load_dwordx4 v[40:43], v1, s[36:39], s52 offen sc1
    s_add_u32 s52, s56, 4096
    buffer_load_dwordx4 v[44:47], v1, s[36:39], s52 offen sc1
    s_add_u32 s52, s54, 5120
    buffer_load_dwordx4 v[48:51], v1, s[36:39], s52 offen sc1
    s_add_u32 s52, s56, 5120
    buffer_load_dwordx4 v[52:55], v1, s[36:39], s52 offen sc1
    s_add_u32 s53, s53, 1
    s_waitcnt vmcnt(0)
    s_cmp_lt_u32 s53, 0x100000
    s_cbranch_scc1 L_i0_49
L_i0ok_50:
L_back_48:
    v_mfma_f32_32x32x16_bf16 v[64:79], v[128:131], v[8:11], v[64:79]
    v_mfma_f32_32x32x16_bf16 v[96:111], v[128:131], v[12:15], v[96:111]
    v_mfma_f32_32x32x16_bf16 v[80:95], v[132:135], v[8:11], v[80:95]
    v_mfma_f32_32x32x16_bf16 v[112:127], v[132:135], v[12:15], v[112:127]
    s_add_u32 s52, s54, 6144
    buffer_load_dwordx4 v[8:11], v1, s[36:39], s52 offen sc1
    s_add_u32 s52, s56, 6144
    buffer_load_dwordx4 v[12:15], v1, s[36:39], s52 offen sc1
    s_add_u32 s52, s54, 7168
    buffer_load_dwordx4 v[128:131], v1, s[36:39], s52 offen sc1
    s_add_u32 s52, s56, 7168
    buffer_load_dwordx4 v[132:135], v1, s[36:39], s52 offen sc1
    s_waitcnt vmcnt(12)
    v_cmp_eq_u32 vcc, -1, v16
    v_cmp_eq_u32 s[62:63], -1, v20
    s_or_b64 vcc, vcc, s[62:63]
    s_cbranch_vccnz L_retry_51
L_back_52:
    v_mfma_f32_32x32x16_bf16 v[64:79], v[136:139], v[16:19], v[64:79]
    v_mfma_f32_32x32x16_bf16 v[96:111], v[136:139], v[20:23], v[96:111]
    v_mfma_f32_32x32x16_bf16 v[80:95], v[140:143], v[16:19], v[80:95]
    v_mfma_f32_32x32x16_bf16 v[112:127], v[140:143], v[20:23], v[112:127]
    s_add_u32 s52, s54, 8192
    buffer_load_dwordx4 v[16:19], v1, s[36:39], s52 offen sc1
    s_add_u32 s52, s56, 8192
    buffer_load_dwordx4 v[20:23], v1, s[36:39], s52 offen sc1
    s_add_u32 s52, s54, 9216
    buffer_load_dwordx4 v[136:139], v1, s[36:39], s52 offen sc1
    s_add_u32 s52, s56, 9216
    buffer_load_dwordx4 v[140:143], v1, s[36:39], s52 offen sc1
    s_waitcnt vmcnt(14)
    v_cmp_eq_u32 vcc, -1, v24
    v_cmp_eq_u32 s[62:63], -1, v28
    s_or_b64 vcc, vcc, s[62:63]
    s_cbranch_vccnz L_retry_53
L_back_54:
    v_mfma_f32_32x32x16_bf16 v[64:79], v[144:147], v[24:27], v[64:79]
    v_mfma_f32_32x32x16_bf16 v[96:111], v[144:147], v[28:31], v[96:111]
    v_mfma_f32_32x32x16_bf16 v[80:95], v[148:151], v[24:27], v[80:95]
    v_mfma_f32_32x32x16_bf16 v[112:127], v[148:151], v[28:31], v[112:127]
    s_add_u32 s52, s54, 10240
    buffer_load_dwordx4 v[24:27], v1, s[36:39], s52 offen sc1
    s_add_u32 s52, s56, 10240
    buffer_load_dwordx4 v[28:31], v1, s[36:39], s52 offen sc1
    s_add_u32 s52, s54, 11264
    buffer_load_dwordx4 v[144:147], v1, s[36:39], s52 offen sc1
    s_add_u32 s52, s56, 11264
    buffer_load_dwordx4 v[148:151], v1, s[36:39], s52 offen sc1
    s_waitcnt vmcnt(16)
    v_cmp_eq_u32 vcc, -1, v32
    v_cmp_eq_u32 s[62:63], -1, v36
    s_or_b64 vcc, vcc, s[62:63]
    s_cbranch_vccnz L_retry_55
L_back_56:
    v_mfma_f32_32x32x16_bf16 v[64:79], v[152:155], v[32:35], v[64:79]
    v_mfma_f32_32x32x16_bf16 v[96:111], v[152:155], v[36:39], v[96:111]
    v_mfma_f32_32x32x16_bf16 v[80:95], v[156:159], v[32:35], v[80:95]
    v_mfma_f32_32x32x16_bf16 v[112:127], v[156:159], v[36:39], v[112:127]
    s_add_u32 s52, s54, 12288
    buffer_load_dwordx4 v[32:35], v1, s[36:39], s52 offen sc1
    s_add_u32 s52, s56, 12288
    buffer_load_dwordx4 v[36:39], v1, s[36:39], s52 offen sc1
    s_add_u32 s52, s54, 13312
    buffer_load_dwordx4 v[152:155], v1, s[36:39], s52 offen sc1
    s_add_u32 s52, s56, 13312
    buffer_load_dwordx4 v[156:159], v1, s[36:39], s52 offen sc1
    s_waitcnt vmcnt(18)
    v_cmp_eq_u32 vcc, -1, v40
    v_cmp_eq_u32 s[62:63], -1, v44
    s_or_b64 vcc, vcc, s[62:63]
    s_cbranch_vccnz L_retry_57
L_back_58:
    v_mfma_f32_32x32x16_bf16 v[64:79], v[160:163], v[40:43], v[64:79]
    v_mfma_f32_32x32x16_bf16 v[96:111], v[160:163], v[44:47], v[96:111]
    v_mfma_f32_32x32x16_bf16 v[80:95], v[164:167], v[40:43], v[80:95]
    v_mfma_f32_32x32x16_bf16 v[112:127], v[164:167], v[44:47], v[112:127]
    s_add_u32 s52, s54, 14336
    buffer_load_dwordx4 v[40:43], v1, s[36:39], s52 offen sc1
    s_add_u32 s52, s56, 14336
    buffer_load_dwordx4 v[44:47], v1, s[36:39], s52 offen sc1
    s_add_u32 s52, s54, 15360
    buffer_load_dwordx4 v[160:163], v1, s[36:39], s52 offen sc1
    s_add_u32 s52, s56, 15360
    buffer_load_dwordx4 v[164:167], v1, s[36:39], s52 offen sc1
    s_waitcnt vmcnt(20)
    v_cmp_eq_u32 vcc, -1, v48
    v_cmp_eq_u32 s[62:63], -1, v52
    s_or_b64 vcc, vcc, s[62:63]
    s_cbranch_vccnz L_retry_59
L_back_60:
    v_mfma_f32_32x32x16_bf16 v[64:79], v[168:171], v[48:51], v[64:79]
    v_mfma_f32_32x32x16_bf16 v[96:111], v[168:171], v[52:55], v[96:111]
    v_mfma_f32_32x32x16_bf16 v[80:95], v[172:175], v[48:51], v[80:95]
    v_mfma_f32_32x32x16_bf16 v[112:127], v[172:175], v[52:55], v[112:127]
    v_add_u32 v2, s57, v61
    v_add_u32 v3, s57, v62
    ds_read_b64_tr_b16 v[168:169], v2 offset:0
    ds_read_b64_tr_b16 v[170:171], v2 offset:1024
    ds_read_b64_tr_b16 v[172:173], v3 offset:0
    ds_read_b64_tr_b16 v[174:175], v3 offset:1024
    s_waitcnt vmcnt(18)
    v_cmp_eq_u32 vcc, -1, v8
    v_cmp_eq_u32 s[62:63], -1, v12
    s_or_b64 vcc, vcc, s[62:63]
    s_cbranch_vccnz L_retry_61
L_back_62:
    v_mfma_f32_32x32x16_bf16 v[64:79], v[176:179], v[8:11], v[64:79]
    v_mfma_f32_32x32x16_bf16 v[96:111], v[176:179], v[12:15], v[96:111]
    v_mfma_f32_32x32x16_bf16 v[80:95], v[180:183], v[8:11], v[80:95]
    v_mfma_f32_32x32x16_bf16 v[112:127], v[180:183], v[12:15], v[112:127]
    v_add_u32 v2, s57, v61
    v_add_u32 v3, s57, v62
    ds_read_b64_tr_b16 v[176:177], v2 offset:2048
    ds_read_b64_tr_b16 v[178:179], v2 offset:3072
    ds_read_b64_tr_b16 v[180:181], v3 offset:2048
    ds_read_b64_tr_b16 v[182:183], v3 offset:3072
    s_waitcnt vmcnt(16)
    v_cmp_eq_u32 vcc, -1, v128
    v_cmp_eq_u32 s[62:63], -1, v132
    s_or_b64 vcc, vcc, s[62:63]
    s_cbranch_vccnz L_retry_63
L_back_64:
    v_mfma_f32_32x32x16_bf16 v[64:79], v[184:187], v[128:131], v[64:79]
    v_mfma_f32_32x32x16_bf16 v[96:111], v[184:187], v[132:135], v[96:111]
    v_mfma_f32_32x32x16_bf16 v[80:95], v[188:191], v[128:131], v[80:95]
    v_mfma_f32_32x32x16_bf16 v[112:127], v[188:191], v[132:135], v[112:127]
    v_add_u32 v2, s57, v61
    v_add_u32 v3, s57, v62
    ds_read_b64_tr_b16 v[184:185], v2 offset:4096
    ds_read_b64_tr_b16 v[186:187], v2 offset:5120
    ds_read_b64_tr_b16 v[188:189], v3 offset:4096
    ds_read_b64_tr_b16 v[190:191], v3 offset:5120
    v_add_u32 v2, s59, v61
    v_add_u32 v3, s59, v62
    ds_read_b64_tr_b16 v[128:129], v2 offset:0
    ds_read_b64_tr_b16 v[130:131], v2 offset:1024
    ds_read_b64_tr_b16 v[132:133], v3 offset:0
    ds_read_b64_tr_b16 v[134:135], v3 offset:1024
    s_waitcnt vmcnt(14)
    v_cmp_eq_u32 vcc, -1, v16
    v_cmp_eq_u32 s[62:63], -1, v20
    s_or_b64 vcc, vcc, s[62:63]
    s_cbranch_vccnz L_retry_65
L_back_66:
    v_mfma_f32_32x32x16_bf16 v[64:79], v[192:195], v[16:19], v[64:79]
    v_mfma_f32_32x32x16_bf16 v[96:111], v[192:195], v[20:23], v[96:111]
    v_mfma_f32_32x32x16_bf16 v[80:95], v[196:199], v[16:19], v[80:95]
    v_mfma_f32_32x32x16_bf16 v[112:127], v[196:199], v[20:23], v[112:127]
    v_add_u32 v2, s57, v61
    v_add_u32 v3, s57, v62
    ds_read_b64_tr_b16 v[192:193], v2 offset:6144
    ds_read_b64_tr_b16 v[194:195], v2 offset:7168
    ds_read_b64_tr_b16 v[196:197], v3 offset:6144
    ds_read_b64_tr_b16 v[198:199], v3 offset:7168
    s_waitcnt vmcnt(12)
    v_cmp_eq_u32 vcc, -1, v136
    v_cmp_eq_u32 s[62:63], -1, v140
    s_or_b64 vcc, vcc, s[62:63]
    s_cbranch_vccnz L_retry_67
L_back_68:
    v_mfma_f32_32x32x16_bf16 v[64:79], v[200:203], v[136:139], v[64:79]
    v_mfma_f32_32x32x16_bf16 v[96:111], v[200:203], v[140:143], v[96:111]
    v_mfma_f32_32x32x16_bf16 v[80:95], v[204:207], v[136:139], v[80:95]
    v_mfma_f32_32x32x16_bf16 v[112:127], v[204:207], v[140:143], v[112:127]
    v_add_u32 v2, s59, v61
    v_add_u32 v3, s59, v62
    ds_read_b64_tr_b16 v[136:137], v2 offset:2048
    ds_read_b64_tr_b16 v[138:139], v2 offset:3072
    ds_read_b64_tr_b16 v[140:141], v3 offset:2048
    ds_read_b64_tr_b16 v[142:143], v3 offset:3072
    s_waitcnt vmcnt(10)
    v_cmp_eq_u32 vcc, -1, v24
    v_cmp_eq_u32 s[62:63], -1, v28
    s_or_b64 vcc, vcc, s[62:63]
    s_cbranch_vccnz L_retry_69
L_back_70:
    v_mfma_f32_32x32x16_bf16 v[64:79], v[208:211], v[24:27], v[64:79]
    v_mfma_f32_32x32x16_bf16 v[96:111], v[208:211], v[28:31], v[96:111]
    v_mfma_f32_32x32x16_bf16 v[80:95], v[212:215], v[24:27], v[80:95]
    v_mfma_f32_32x32x16_bf16 v[112:127], v[212:215], v[28:31], v[112:127]
    s_waitcnt vmcnt(8)
    v_cmp_eq_u32 vcc, -1, v144
    v_cmp_eq_u32 s[62:63], -1, v148
    s_or_b64 vcc, vcc, s[62:63]
    s_cbranch_vccnz L_retry_71
L_back_72:
    v_mfma_f32_32x32x16_bf16 v[64:79], v[216:219], v[144:147], v[64:79]
    v_mfma_f32_32x32x16_bf16 v[96:111], v[216:219], v[148:151], v[96:111]
    v_mfma_f32_32x32x16_bf16 v[80:95], v[220:223], v[144:147], v[80:95]
    v_mfma_f32_32x32x16_bf16 v[112:127], v[220:223], v[148:151], v[112:127]
    v_add_u32 v2, s59, v61
    v_add_u32 v3, s59, v62
    ds_read_b64_tr_b16 v[144:145], v2 offset:4096
    ds_read_b64_tr_b16 v[146:147], v2 offset:5120
    ds_read_b64_tr_b16 v[148:149], v3 offset:4096
    ds_read_b64_tr_b16 v[150:151], v3 offset:5120
    s_waitcnt vmcnt(6)
    v_cmp_eq_u32 vcc, -1, v32
    v_cmp_eq_u32 s[62:63], -1, v36
    s_or_b64 vcc, vcc, s[62:63]
    s_cbranch_vccnz L_retry_73
L_back_74:
    v_mfma_f32_32x32x16_bf16 v[64:79], v[224:227], v[32:35], v[64:79]
    v_mfma_f32_32x32x16_bf16 v[96:111], v[224:227], v[36:39], v[96:111]
    v_mfma_f32_32x32x16_bf16 v[80:95], v[228:231], v[32:35], v[80:95]
    v_mfma_f32_32x32x16_bf16 v[112:127], v[228:231], v[36:39], v[112:127]
    s_waitcnt vmcnt(4)
    v_cmp_eq_u32 vcc, -1, v152
    v_cmp_eq_u32 s[62:63], -1, v156
    s_or_b64 vcc, vcc, s[62:63]
    s_cbranch_vccnz L_retry_75
L_back_76:
    v_mfma_f32_32x32x16_bf16 v[64:79], v[232:235], v[152:155], v[64:79]
    v_mfma_f32_32x32x16_bf16 v[96:111], v[232:235], v[156:159], v[96:111]
    v_mfma_f32_32x32x16_bf16 v[80:95], v[236:239], v[152:155], v[80:95]
    v_mfma_f32_32x32x16_bf16 v[112:127], v[236:239], v[156:159], v[112:127]
    v_add_u32 v2, s59, v61
    v_add_u32 v3, s59, v62
    ds_read_b64_tr_b16 v[152:153], v2 offset:6144
    ds_read_b64_tr_b16 v[154:155], v2 offset:7168
    ds_read_b64_tr_b16 v[156:157], v3 offset:6144
    ds_read_b64_tr_b16 v[158:159], v3 offset:7168
    s_waitcnt vmcnt(2)
    v_cmp_eq_u32 vcc, -1, v40
    v_cmp_eq_u32 s[62:63], -1, v44
    s_or_b64 vcc, vcc, s[62:63]
    s_cbranch_vccnz L_retry_77
L_back_78:
    v_mfma_f32_32x32x16_bf16 v[64:79], v[240:243], v[40:43], v[64:79]
    v_mfma_f32_32x32x16_bf16 v[96:111], v[240:243], v[44:47], v[96:111]
    v_mfma_f32_32x32x16_bf16 v[80:95], v[244:247], v[40:43], v[80:95]
    v_mfma_f32_32x32x16_bf16 v[112:127], v[244:247], v[44:47], v[112:127]
    s_waitcnt vmcnt(0)
    v_cmp_eq_u32 vcc, -1, v160
    v_cmp_eq_u32 s[62:63], -1, v164
    s_or_b64 vcc, vcc, s[62:63]
    s_cbranch_vccnz L_retry_79
L_back_80:
    v_mfma_f32_32x32x16_bf16 v[64:79], v[248:251], v[160:163], v[64:79]
    v_mfma_f32_32x32x16_bf16 v[96:111], v[248:251], v[164:167], v[96:111]
    v_mfma_f32_32x32x16_bf16 v[80:95], v[252:255], v[160:163], v[80:95]
    v_mfma_f32_32x32x16_bf16 v[112:127], v[252:255], v[164:167], v[112:127]
    v_add_u32 v2, s55, v61
    v_add_u32 v3, s55, v62
    ds_read_b64_tr_b16 v[160:161], v2 offset:0
    ds_read_b64_tr_b16 v[162:163], v2 offset:1024
    ds_read_b64_tr_b16 v[164:165], v3 offset:0
    ds_read_b64_tr_b16 v[166:167], v3 offset:1024
    s_nop 7
    s_nop 3
    v_add_u32 v2, s59, v1
    v_add_u32 v3, s57, v1
    s_waitcnt lgkmcnt(0)
    ds_write_b128 v2, v[64:67] offset:0
    ds_write_b128 v2, v[68:71] offset:1024
    ds_write_b128 v2, v[80:83] offset:2048
    ds_write_b128 v2, v[84:87] offset:3072
    ds_write_b128 v2, v[72:75] offset:4096
    ds_write_b128 v2, v[76:79] offset:5120
    ds_write_b128 v2, v[88:91] offset:6144
    ds_write_b128 v2, v[92:95] offset:7168
    ds_write_b128 v3, v[96:99] offset:0
    ds_write_b128 v3, v[100:103] offset:1024
    ds_write_b128 v3, v[112:115] offset:2048
    ds_write_b128 v3, v[116:119] offset:3072
    ds_write_b128 v3, v[104:107] offset:4096
    ds_write_b128 v3, v[108:111] offset:5120
    ds_write_b128 v3, v[120:123] offset:6144
    ds_write_b128 v3, v[124:127] offset:7168
    s_and_b32 s46, s3, 3
    s_lshl_b32 s46, s46, 11
    s_mov_b32 s48, 65536
    s_cmp_lt_u32 s3, 4
    s_cselect_b32 s47, 98304, 0
    s_cselect_b32 s48, 32768, s48
    s_add_u32 s46, s46, s47
    v_add_u32 v2, s46, v1
    v_add_u32 v3, s48, v2
    s_waitcnt lgkmcnt(0)
    s_barrier
    ds_read_b128 v[64:67], v2 offset:0
    ds_read_b128 v[68:71], v2 offset:1024
    ds_read_b128 v[72:75], v2 offset:8192
    ds_read_b128 v[76:79], v2 offset:9216
    ds_read_b128 v[80:83], v2 offset:16384
    ds_read_b128 v[84:87], v2 offset:17408
    ds_read_b128 v[88:91], v2 offset:24576
    ds_read_b128 v[92:95], v2 offset:25600
    ds_read_b128 v[96:99], v3 offset:0
    ds_read_b128 v[100:103], v3 offset:1024
    ds_read_b128 v[104:107], v3 offset:8192
    ds_read_b128 v[108:111], v3 offset:9216
    ds_read_b128 v[112:115], v3 offset:16384
    ds_read_b128 v[116:119], v3 offset:17408
    ds_read_b128 v[120:123], v3 offset:24576
    ds_read_b128 v[124:127], v3 offset:25600
    s_waitcnt lgkmcnt(12)
    v_add_f32 v64, v64, v72
    v_add_f32 v65, v65, v73
    v_add_f32 v66, v66, v74
    v_add_f32 v67, v67, v75
    v_add_f32 v68, v68, v76
    v_add_f32 v69, v69, v77
    v_add_f32 v70, v70, v78
    v_add_f32 v71, v71, v79
    s_waitcnt lgkmcnt(8)
    v_add_f32 v80, v80, v88
    v_add_f32 v81, v81, v89
    v_add_f32 v82, v82, v90
    v_add_f32 v83, v83, v91
    v_add_f32 v84, v84, v92
    v_add_f32 v85, v85, v93
    v_add_f32 v86, v86, v94
    v_add_f32 v87, v87, v95
    s_waitcnt lgkmcnt(4)
    v_add_f32 v96, v96, v104
    v_add_f32 v97, v97, v105
    v_add_f32 v98, v98, v106
    v_add_f32 v99, v99, v107
    v_add_f32 v100, v100, v108
    v_add_f32 v101, v101, v109
    v_add_f32 v102, v102, v110
    v_add_f32 v103, v103, v111
    s_waitcnt lgkmcnt(0)
    v_add_f32 v112, v112, v120
    v_add_f32 v113, v113, v121
    v_add_f32 v114, v114, v122
    v_add_f32 v115, v115, v123
    v_add_f32 v116, v116, v124
    v_add_f32 v117, v117, v125
    v_add_f32 v118, v118, v126
    v_add_f32 v119, v119, v127
    s_barrier
    v_add_f32 v64, v64, v80
    v_add_f32 v65, v65, v81
    v_add_f32 v66, v66, v82
    v_add_f32 v67, v67, v83
    v_add_f32 v68, v68, v84
    v_add_f32 v69, v69, v85
    v_add_f32 v70, v70, v86
    v_add_f32 v71, v71, v87
    v_add_f32 v96, v96, v112
    v_add_f32 v97, v97, v113
    v_add_f32 v98, v98, v114
    v_add_f32 v99, v99, v115
    v_add_f32 v100, v100, v116
    v_add_f32 v101, v101, v117
    v_add_f32 v102, v102, v118
    v_add_f32 v103, v103, v119
    v_add_f32 v64, v64, v96
    v_add_f32 v65, v65, v97
    v_add_f32 v66, v66, v98
    v_add_f32 v67, v67, v99
    v_add_f32 v68, v68, v100
    v_add_f32 v69, v69, v101
    v_add_f32 v70, v70, v102
    v_add_f32 v71, v71, v103
    v_lshlrev_b32 v16, 16, v56
    v_and_b32 v17, 0xffff0000, v56
    v_lshlrev_b32 v18, 16, v57
    v_and_b32 v19, 0xffff0000, v57
    v_lshlrev_b32 v20, 16, v58
    v_and_b32 v21, 0xffff0000, v58
    v_lshlrev_b32 v22, 16, v59
    v_and_b32 v23, 0xffff0000, v59
    v_add_f32 v64, v64, v16
    v_add_f32 v65, v65, v17
    v_add_f32 v66, v66, v18
    v_add_f32 v67, v67, v19
    v_add_f32 v68, v68, v20
    v_add_f32 v69, v69, v21
    v_add_f32 v70, v70, v22
    v_add_f32 v71, v71, v23
    s_mov_b32 s46, 0xc0135761
    s_mov_b32 s47, 0xbdd2d3e8
    v_mov_b32 v24, s46
    v_mul_f32 v16, v64, v64
    v_mul_f32 v17, v65, v65
    v_mul_f32 v18, v66, v66
    v_mul_f32 v19, v67, v67
    v_mul_f32 v20, v68, v68
    v_mul_f32 v21, v69, v69
    v_mul_f32 v22, v70, v70
    v_mul_f32 v23, v71, v71
    v_fma_f32 v16, v16, s47, v24
    v_fma_f32 v17, v17, s47, v24
    v_fma_f32 v18, v18, s47, v24
    v_fma_f32 v19, v19, s47, v24
    v_fma_f32 v20, v20, s47, v24
    v_fma_f32 v21, v21, s47, v24
    v_fma_f32 v22, v22, s47, v24
    v_fma_f32 v23, v23, s47, v24
    v_mul_f32 v16, v16, v64
    v_mul_f32 v17, v17, v65
    v_mul_f32 v18, v18, v66
    v_mul_f32 v19, v19, v67
    v_mul_f32 v20, v20, v68
    v_mul_f32 v21, v21, v69
    v_mul_f32 v22, v22, v70
    v_mul_f32 v23, v23, v71
    v_exp_f32 v16, v16
    v_exp_f32 v17, v17
    v_exp_f32 v18, v18
    v_exp_f32 v19, v19
    v_exp_f32 v20, v20
    v_exp_f32 v21, v21
    v_exp_f32 v22, v22
    v_exp_f32 v23, v23
    v_add_f32 v16, 1.0, v16
    v_add_f32 v17, 1.0, v17
    v_add_f32 v18, 1.0, v18
    v_add_f32 v19, 1.0, v19
    v_add_f32 v20, 1.0, v20
    v_add_f32 v21, 1.0, v21
    v_add_f32 v22, 1.0, v22
    v_add_f32 v23, 1.0, v23
    v_rcp_f32 v16, v16
    v_rcp_f32 v17, v17
    v_rcp_f32 v18, v18
    v_rcp_f32 v19, v19
    v_rcp_f32 v20, v20
    v_rcp_f32 v21, v21
    v_rcp_f32 v22, v22
    v_rcp_f32 v23, v23
    v_mul_f32 v16, v16, v64
    v_mul_f32 v17, v17, v65
    v_mul_f32 v18, v18, v66
    v_mul_f32 v19, v19, v67
    v_mul_f32 v20, v20, v68
    v_mul_f32 v21, v21, v69
    v_mul_f32 v22, v22, v70
    v_mul_f32 v23, v23, v71
    v_cvt_pk_bf16_f32 v28, v16, v17
    v_cvt_pk_bf16_f32 v29, v18, v19
    v_cvt_pk_bf16_f32 v30, v20, v21
    v_cvt_pk_bf16_f32 v31, v22, v23
    v_min_u32 v28, 0xfffffffe, v28
    s_cmp_eq_u32 s100, 0
    s_cbranch_scc1 L_nostu_81
    buffer_store_dwordx4 v[28:31], v1, s[36:39], s98 offen sc1
L_nostu_81:
L_p4_join_46:
    s_barrier
    s_mov_b32 m0, s59
    s_mov_b32 s60, 589824
    buffer_load_dwordx4 v60, s[28:31], s60 offen lds
    s_add_u32 m0, s59, 1024
    s_mov_b32 s60, 622592
    buffer_load_dwordx4 v60, s[28:31], s60 offen lds
    s_add_u32 m0, s59, 2048
    s_mov_b32 s60, 655360
    buffer_load_dwordx4 v60, s[28:31], s60 offen lds
    s_add_u32 m0, s59, 3072
    s_mov_b32 s60, 688128
    buffer_load_dwordx4 v60, s[28:31], s60 offen lds
    s_add_u32 m0, s59, 4096
    s_mov_b32 s60, 720896
    buffer_load_dwordx4 v60, s[28:31], s60 offen lds
    s_add_u32 m0, s59, 5120
    s_mov_b32 s60, 753664
    buffer_load_dwordx4 v60, s[28:31], s60 offen lds
    s_add_u32 m0, s59, 6144
    s_mov_b32 s60, 786432
    buffer_load_dwordx4 v60, s[28:31], s60 offen lds
    s_add_u32 m0, s59, 7168
    s_mov_b32 s60, 819200
    buffer_load_dwordx4 v60, s[28:31], s60 offen lds
    s_mov_b32 m0, s55
    s_mov_b32 s60, 851968
    buffer_load_dwordx4 v60, s[28:31], s60 offen lds
    s_add_u32 m0, s55, 1024
    s_mov_b32 s60, 884736
    buffer_load_dwordx4 v60, s[28:31], s60 offen lds
    s_and_b32 s46, s2, 7
    s_lshr_b32 s47, s2, 3
    s_lshl_b32 s48, s46, 2
    s_lshr_b32 s49, s47, 3
    s_add_u32 s27, s48, s49
    s_and_b32 s26, s47, 7
    s_mov_b32 s32, s18
    s_mov_b32 s33, s19
    s_mov_b32 s34, 0x1000
    s_mov_b32 s35, 0x20000
    s_mov_b32 s40, s20
    s_mov_b32 s41, s21
    s_mov_b32 s42, 0x200000
    s_mov_b32 s43, 0x20000
    s_lshl_b32 s46, s27, 6
    s_and_b32 s47, s3, 1
    s_lshl_b32 s47, s47, 5
    s_add_u32 s46, s46, s47
    v_and_b32 v2, 31, v0
    v_add_u32 v57, s46, v2
    v_lshlrev_b32 v2, 1, v57
    buffer_load_ushort v63, v2, s[32:35], 0 offen
    s_mul_i32 s46, s26, 229376
    s_mul_i32 s47, s3, 14336
    s_add_u32 s46, s46, s47
    s_add_u32 s54, s46, 12582912
    s_add_u32 s56, s46, 12697600
    s_cmp_lg_u32 s100, 0
    s_cbranch_scc1 L_p5_busy_82
    s_cmp_lg_u32 s3, 7
    s_cbranch_scc1 L_p5_w_83
    v_lshrrev_b32 v2, 1, v0
    v_mov_b32 v3, 1
    v_cmp_eq_u32 vcc, 1, v2
    v_mov_b32 v8, 5
    s_nop 0
    v_cndmask_b32 v3, v3, v8, vcc
    v_cmp_eq_u32 vcc, 2, v2
    v_mov_b32 v8, 9
    s_nop 0
    v_cndmask_b32 v3, v3, v8, vcc
    v_cmp_eq_u32 vcc, 3, v2
    v_mov_b32 v8, 13
    s_nop 0
    v_cndmask_b32 v3, v3, v8, vcc
    v_lshlrev_b32 v3, 10, v3
    v_add_u32 v3, 1008, v3
    v_and_b32 v2, 1, v0
    s_sub_u32 s52, s56, s54
    v_mul_lo_u32 v2, v2, s52
    v_add_u32 v3, v3, v2
    s_mov_b32 s53, 0
    v_cmp_gt_u32 vcc, 8, v0
    s_and_saveexec_b64 s[62:63], vcc
L_probe_84:
    buffer_load_dword v8, v3, s[36:39], s54 offen sc1
    s_add_u32 s53, s53, 1
    s_waitcnt vmcnt(0)
    v_cmp_eq_u32 vcc, -1, v8
    s_cbranch_vccz L_px_85
    s_cmp_lt_u32 s53, 0x100000
    s_cbranch_scc1 L_probe_84
L_px_85:
    s_mov_b64 exec, s[62:63]
L_p5_w_83:
    s_barrier
L_p5_busy_82:
    s_waitcnt vmcnt(10)
    s_nop 0
    s_add_u32 s52, s54, 0
    buffer_load_dwordx4 v[8:11], v1, s[36:39], s52 offen sc1
    s_add_u32 s52, s56, 0
    buffer_load_dwordx4 v[12:15], v1, s[36:39], s52 offen sc1
    s_add_u32 s52, s54, 1024
    buffer_load_dwordx4 v[16:19], v1, s[36:39], s52 offen sc1
    s_add_u32 s52, s56, 1024
    buffer_load_dwordx4 v[20:23], v1, s[36:39], s52 offen sc1
    s_add_u32 s52, s54, 2048
    buffer_load_dwordx4 v[24:27], v1, s[36:39], s52 offen sc1
    s_add_u32 s52, s56, 2048
    buffer_load_dwordx4 v[28:31], v1, s[36:39], s52 offen sc1
    s_add_u32 s52, s54, 3072
    buffer_load_dwordx4 v[32:35], v1, s[36:39], s52 offen sc1
    s_add_u32 s52, s56, 3072
    buffer_load_dwordx4 v[36:39], v1, s[36:39], s52 offen sc1
    s_add_u32 s52, s54, 4096
    buffer_load_dwordx4 v[40:43], v1, s[36:39], s52 offen sc1
    s_add_u32 s52, s56, 4096
    buffer_load_dwordx4 v[44:47], v1, s[36:39], s52 offen sc1
    s_add_u32 s52, s54, 5120
    buffer_load_dwordx4 v[48:51], v1, s[36:39], s52 offen sc1
    s_add_u32 s52, s56, 5120
    buffer_load_dwordx4 v[52:55], v1, s[36:39], s52 offen sc1
    v_mov_b32 v64, 0
    v_mov_b32 v65, 0
    v_mov_b32 v66, 0
    v_mov_b32 v67, 0
    v_mov_b32 v68, 0
    v_mov_b32 v69, 0
    v_mov_b32 v70, 0
    v_mov_b32 v71, 0
    v_mov_b32 v72, 0
    v_mov_b32 v73, 0
    v_mov_b32 v74, 0
    v_mov_b32 v75, 0
    v_mov_b32 v76, 0
    v_mov_b32 v77, 0
    v_mov_b32 v78, 0
    v_mov_b32 v79, 0
    v_mov_b32 v80, 0
    v_mov_b32 v81, 0
    v_mov_b32 v82, 0
    v_mov_b32 v83, 0
    v_mov_b32 v84, 0
    v_mov_b32 v85, 0
    v_mov_b32 v86, 0
    v_mov_b32 v87, 0
    v_mov_b32 v88, 0
    v_mov_b32 v89, 0
    v_mov_b32 v90, 0
    v_mov_b32 v91, 0
    v_mov_b32 v92, 0
    v_mov_b32 v93, 0
    v_mov_b32 v94, 0
    v_mov_b32 v95, 0
    v_mov_b32 v96, 0
    v_mov_b32 v97, 0
    v_mov_b32 v98, 0
    v_mov_b32 v99, 0
    v_mov_b32 v100, 0
    v_mov_b32 v101, 0
    v_mov_b32 v102, 0
    v_mov_b32 v103, 0
    v_mov_b32 v104, 0
    v_mov_b32 v105, 0
    v_mov_b32 v106, 0
    v_mov_b32 v107, 0
    v_mov_b32 v108, 0
    v_mov_b32 v109, 0
    v_mov_b32 v110, 0
    v_mov_b32 v111, 0
    v_mov_b32 v112, 0
    v_mov_b32 v113, 0
    v_mov_b32 v114, 0
    v_mov_b32 v115, 0
    v_mov_b32 v116, 0
    v_mov_b32 v117, 0
    v_mov_b32 v118, 0
    v_mov_b32 v119, 0
    v_mov_b32 v120, 0
    v_mov_b32 v121, 0
    v_mov_b32 v122, 0
    v_mov_b32 v123, 0
    v_mov_b32 v124, 0
    v_mov_b32 v125, 0
    v_mov_b32 v126, 0
    v_mov_b32 v127, 0
    s_waitcnt vmcnt(10)
    s_mov_b32 s53, 0
L_i0_88:
    v_cmp_eq_u32 vcc, -1, v8
    v_cmp_eq_u32 s[62:63], -1, v12
    s_or_b64 vcc, vcc, s[62:63]
    s_cbranch_vccz L_i0ok_89
    s_add_u32 s52, s54, 0
    buffer_load_dwordx4 v[8:11], v1, s[36:39], s52 offen sc1
    s_add_u32 s52, s56, 0
    buffer_load_dwordx4 v[12:15], v1, s[36:39], s52 offen sc1
    s_add_u32 s52, s54, 1024
    buffer_load_dwordx4 v[16:19], v1, s[36:39], s52 offen sc1
    s_add_u32 s52, s56, 1024
    buffer_load_dwordx4 v[20:23], v1, s[36:39], s52 offen sc1
    s_add_u32 s52, s54, 2048
    buffer_load_dwordx4 v[24:27], v1, s[36:39], s52 offen sc1
    s_add_u32 s52, s56, 2048
    buffer_load_dwordx4 v[28:31], v1, s[36:39], s52 offen sc1
    s_add_u32 s52, s54, 3072
    buffer_load_dwordx4 v[32:35], v1, s[36:39], s52 offen sc1
    s_add_u32 s52, s56, 3072
    buffer_load_dwordx4 v[36:39], v1, s[36:39], s52 offen sc1
    s_add_u32 s52, s54, 4096
    buffer_load_dwordx4 v[40:43], v1, s[36:39], s52 offen sc1
    s_add_u32 s52, s56, 4096
    buffer_load_dwordx4 v[44:47], v1, s[36:39], s52 offen sc1
    s_add_u32 s52, s54, 5120
    buffer_load_dwordx4 v[48:51], v1, s[36:39], s52 offen sc1
    s_add_u32 s52, s56, 5120
    buffer_load_dwordx4 v[52:55], v1, s[36:39], s52 offen sc1
    s_add_u32 s53, s53, 1
    s_waitcnt vmcnt(0)
    s_cmp_lt_u32 s53, 0x100000
    s_cbranch_scc1 L_i0_88
L_i0ok_89:
L_back_87:
    v_mfma_f32_32x32x16_bf16 v[64:79], v[8:11], v[128:131], v[64:79]
    v_mfma_f32_32x32x16_bf16 v[96:111], v[12:15], v[128:131], v[96:111]
    v_mfma_f32_32x32x16_bf16 v[80:95], v[8:11], v[132:135], v[80:95]
    v_mfma_f32_32x32x16_bf16 v[112:127], v[12:15], v[132:135], v[112:127]
    s_add_u32 s52, s54, 6144
    buffer_load_dwordx4 v[8:11], v1, s[36:39], s52 offen sc1
    s_add_u32 s52, s56, 6144
    buffer_load_dwordx4 v[12:15], v1, s[36:39], s52 offen sc1
    s_add_u32 s52, s54, 7168
    buffer_load_dwordx4 v[200:203], v1, s[36:39], s52 offen sc1
    s_add_u32 s52, s56, 7168
    buffer_load_dwordx4 v[204:207], v1, s[36:39], s52 offen sc1
    s_add_u32 s52, s54, 8192
    buffer_load_dwordx4 v[208:211], v1, s[36:39], s52 offen sc1
    s_add_u32 s52, s56, 8192
    buffer_load_dwordx4 v[212:215], v1, s[36:39], s52 offen sc1
    s_waitcnt vmcnt(14)
    v_cmp_eq_u32 vcc, -1, v16
    v_cmp_eq_u32 s[62:63], -1, v20
    s_or_b64 vcc, vcc, s[62:63]
    s_cbranch_vccnz L_retry_90
L_back_91:
    v_mfma_f32_32x32x16_bf16 v[64:79], v[16:19], v[136:139], v[64:79]
    v_mfma_f32_32x32x16_bf16 v[96:111], v[20:23], v[136:139], v[96:111]
    v_mfma_f32_32x32x16_bf16 v[80:95], v[16:19], v[140:143], v[80:95]
    v_mfma_f32_32x32x16_bf16 v[112:127], v[20:23], v[140:143], v[112:127]
    s_add_u32 s52, s54, 9216
    buffer_load_dwordx4 v[16:19], v1, s[36:39], s52 offen sc1
    s_add_u32 s52, s56, 9216
    buffer_load_dwordx4 v[20:23], v1, s[36:39], s52 offen sc1
    s_add_u32 s52, s54, 10240
    buffer_load_dwordx4 v[216:219], v1, s[36:39], s52 offen sc1
    s_add_u32 s52, s56, 10240
    buffer_load_dwordx4 v[220:223], v1, s[36:39], s52 offen sc1
    s_add_u32 s52, s54, 11264
    buffer_load_dwordx4 v[224:227], v1, s[36:39], s52 offen sc1
    s_add_u32 s52, s56, 11264
    buffer_load_dwordx4 v[228:231], v1, s[36:39], s52 offen sc1
    s_waitcnt vmcnt(18)
    v_cmp_eq_u32 vcc, -1, v24
    v_cmp_eq_u32 s[62:63], -1, v28
    s_or_b64 vcc, vcc, s[62:63]
    s_cbranch_vccnz L_retry_92
L_back_93:
    v_mfma_f32_32x32x16_bf16 v[64:79], v[24:27], v[144:147], v[64:79]
    v_mfma_f32_32x32x16_bf16 v[96:111], v[28:31], v[144:147], v[96:111]
    v_mfma_f32_32x32x16_bf16 v[80:95], v[24:27], v[148:151], v[80:95]
    v_mfma_f32_32x32x16_bf16 v[112:127], v[28:31], v[148:151], v[112:127]
    s_add_u32 s52, s54, 12288
    buffer_load_dwordx4 v[24:27], v1, s[36:39], s52 offen sc1
    s_add_u32 s52, s56, 12288
    buffer_load_dwordx4 v[28:31], v1, s[36:39], s52 offen sc1
    s_add_u32 s52, s54, 13312
    buffer_load_dwordx4 v[232:235], v1, s[36:39], s52 offen sc1
    s_add_u32 s52, s56, 13312
    buffer_load_dwordx4 v[236:239], v1, s[36:39], s52 offen sc1
    s_waitcnt vmcnt(20)
    v_cmp_eq_u32 vcc, -1, v32
    v_cmp_eq_u32 s[62:63], -1, v36
    s_or_b64 vcc, vcc, s[62:63]
    s_cbranch_vccnz L_retry_94
L_back_95:
    v_mfma_f32_32x32x16_bf16 v[64:79], v[32:35], v[152:155], v[64:79]
    v_mfma_f32_32x32x16_bf16 v[96:111], v[36:39], v[152:155], v[96:111]
    v_mfma_f32_32x32x16_bf16 v[80:95], v[32:35], v[156:159], v[80:95]
    v_mfma_f32_32x32x16_bf16 v[112:127], v[36:39], v[156:159], v[112:127]
    s_waitcnt vmcnt(18)
    v_cmp_eq_u32 vcc, -1, v40
    v_cmp_eq_u32 s[62:63], -1, v44
    s_or_b64 vcc, vcc, s[62:63]
    s_cbranch_vccnz L_retry_96
L_back_97:
    v_mfma_f32_32x32x16_bf16 v[64:79], v[40:43], v[160:163], v[64:79]
    v_mfma_f32_32x32x16_bf16 v[96:111], v[44:47], v[160:163], v[96:111]
    v_mfma_f32_32x32x16_bf16 v[80:95], v[40:43], v[164:167], v[80:95]
    v_mfma_f32_32x32x16_bf16 v[112:127], v[44:47], v[164:167], v[112:127]
    s_waitcnt vmcnt(16)
    v_cmp_eq_u32 vcc, -1, v48
    v_cmp_eq_u32 s[62:63], -1, v52
    s_or_b64 vcc, vcc, s[62:63]
    s_cbranch_vccnz L_retry_98
L_back_99:
    v_mfma_f32_32x32x16_bf16 v[64:79], v[48:51], v[168:171], v[64:79]
    v_mfma_f32_32x32x16_bf16 v[96:111], v[52:55], v[168:171], v[96:111]
    v_mfma_f32_32x32x16_bf16 v[80:95], v[48:51], v[172:175], v[80:95]
    v_mfma_f32_32x32x16_bf16 v[112:127], v[52:55], v[172:175], v[112:127]
    s_waitcnt vmcnt(14)
    v_cmp_eq_u32 vcc, -1, v8
    v_cmp_eq_u32 s[62:63], -1, v12
    s_or_b64 vcc, vcc, s[62:63]
    s_cbranch_vccnz L_retry_100
L_back_101:
    v_mfma_f32_32x32x16_bf16 v[64:79], v[8:11], v[176:179], v[64:79]
    v_mfma_f32_32x32x16_bf16 v[96:111], v[12:15], v[176:179], v[96:111]
    v_mfma_f32_32x32x16_bf16 v[80:95], v[8:11], v[180:183], v[80:95]
    v_mfma_f32_32x32x16_bf16 v[112:127], v[12:15], v[180:183], v[112:127]
    v_add_u32 v2, s59, v61
    v_add_u32 v3, s59, v62
    ds_read_b64_tr_b16 v[240:241], v2 offset:0
    ds_read_b64_tr_b16 v[242:243], v2 offset:1024
    ds_read_b64_tr_b16 v[244:245], v3 offset:0
    ds_read_b64_tr_b16 v[246:247], v3 offset:1024
    v_add_u32 v2, s59, v61
    v_add_u32 v3, s59, v62
    ds_read_b64_tr_b16 v[248:249], v2 offset:2048
    ds_read_b64_tr_b16 v[250:251], v2 offset:3072
    ds_read_b64_tr_b16 v[252:253], v3 offset:2048
    ds_read_b64_tr_b16 v[254:255], v3 offset:3072
    s_waitcnt vmcnt(12)
    v_cmp_eq_u32 vcc, -1, v200
    v_cmp_eq_u32 s[62:63], -1, v204
    s_or_b64 vcc, vcc, s[62:63]
    s_cbranch_vccnz L_retry_102
L_back_103:
    v_mfma_f32_32x32x16_bf16 v[64:79], v[200:203], v[184:187], v[64:79]
    v_mfma_f32_32x32x16_bf16 v[96:111], v[204:207], v[184:187], v[96:111]
    v_mfma_f32_32x32x16_bf16 v[80:95], v[200:203], v[188:191], v[80:95]
    v_mfma_f32_32x32x16_bf16 v[112:127], v[204:207], v[188:191], v[112:127]
    v_add_u32 v2, s59, v61
    v_add_u32 v3, s59, v62
    ds_read_b64_tr_b16 v[32:33], v2 offset:4096
    ds_read_b64_tr_b16 v[34:35], v2 offset:5120
    ds_read_b64_tr_b16 v[36:37], v3 offset:4096
    ds_read_b64_tr_b16 v[38:39], v3 offset:5120
    v_add_u32 v2, s59, v61
    v_add_u32 v3, s59, v62
    ds_read_b64_tr_b16 v[40:41], v2 offset:6144
    ds_read_b64_tr_b16 v[42:43], v2 offset:7168
    ds_read_b64_tr_b16 v[44:45], v3 offset:6144
    ds_read_b64_tr_b16 v[46:47], v3 offset:7168
    s_waitcnt vmcnt(10)
    v_cmp_eq_u32 vcc, -1, v208
    v_cmp_eq_u32 s[62:63], -1, v212
    s_or_b64 vcc, vcc, s[62:63]
    s_cbranch_vccnz L_retry_104
L_back_105:
    v_mfma_f32_32x32x16_bf16 v[64:79], v[208:211], v[192:195], v[64:79]
    v_mfma_f32_32x32x16_bf16 v[96:111], v[212:215], v[192:195], v[96:111]
    v_mfma_f32_32x32x16_bf16 v[80:95], v[208:211], v[196:199], v[80:95]
    v_mfma_f32_32x32x16_bf16 v[112:127], v[212:215], v[196:199], v[112:127]
    s_waitcnt lgkmcnt(8)
    v_add_u32 v2, s55, v61
    v_add_u32 v3, s55, v62
    ds_read_b64_tr_b16 v[48:49], v2 offset:0
    ds_read_b64_tr_b16 v[50:51], v2 offset:1024
    ds_read_b64_tr_b16 v[52:53], v3 offset:0
    ds_read_b64_tr_b16 v[54:55], v3 offset:1024
    s_waitcnt lgkmcnt(4)
    s_waitcnt vmcnt(8)
    v_cmp_eq_u32 vcc, -1, v16
    v_cmp_eq_u32 s[62:63], -1, v20
    s_or_b64 vcc, vcc, s[62:63]
    s_cbranch_vccnz L_retry_106
L_back_107:
    v_mfma_f32_32x32x16_bf16 v[64:79], v[16:19], v[240:243], v[64:79]
    v_mfma_f32_32x32x16_bf16 v[96:111], v[20:23], v[240:243], v[96:111]
    v_mfma_f32_32x32x16_bf16 v[80:95], v[16:19], v[244:247], v[80:95]
    v_mfma_f32_32x32x16_bf16 v[112:127], v[20:23], v[244:247], v[112:127]
    s_waitcnt vmcnt(6)
    v_cmp_eq_u32 vcc, -1, v216
    v_cmp_eq_u32 s[62:63], -1, v220
    s_or_b64 vcc, vcc, s[62:63]
    s_cbranch_vccnz L_retry_108
L_back_109:
    v_mfma_f32_32x32x16_bf16 v[64:79], v[216:219], v[248:251], v[64:79]
    v_mfma_f32_32x32x16_bf16 v[96:111], v[220:223], v[248:251], v[96:111]
    v_mfma_f32_32x32x16_bf16 v[80:95], v[216:219], v[252:255], v[80:95]
    v_mfma_f32_32x32x16_bf16 v[112:127], v[220:223], v[252:255], v[112:127]
    s_waitcnt vmcnt(4)
    v_cmp_eq_u32 vcc, -1, v224
    v_cmp_eq_u32 s[62:63], -1, v228
    s_or_b64 vcc, vcc, s[62:63]
    s_cbranch_vccnz L_retry_110
L_back_111:
    v_mfma_f32_32x32x16_bf16 v[64:79], v[224:227], v[32:35], v[64:79]
    v_mfma_f32_32x32x16_bf16 v[96:111], v[228:231], v[32:35], v[96:111]
    v_mfma_f32_32x32x16_bf16 v[80:95], v[224:227], v[36:39], v[80:95]
    v_mfma_f32_32x32x16_bf16 v[112:127], v[228:231], v[36:39], v[112:127]
    s_waitcnt lgkmcnt(0)
    s_waitcnt vmcnt(2)
    v_cmp_eq_u32 vcc, -1, v24
    v_cmp_eq_u32 s[62:63], -1, v28
    s_or_b64 vcc, vcc, s[62:63]
    s_cbranch_vccnz L_retry_112
L_back_113:
    v_mfma_f32_32x32x16_bf16 v[64:79], v[24:27], v[40:43], v[64:79]
    v_mfma_f32_32x32x16_bf16 v[96:111], v[28:31], v[40:43], v[96:111]
    v_mfma_f32_32x32x16_bf16 v[80:95], v[24:27], v[44:47], v[80:95]
    v_mfma_f32_32x32x16_bf16 v[112:127], v[28:31], v[44:47], v[112:127]
    s_waitcnt vmcnt(0)
    v_cmp_eq_u32 vcc, -1, v232
    v_cmp_eq_u32 s[62:63], -1, v236
    s_or_b64 vcc, vcc, s[62:63]
    s_cbranch_vccnz L_retry_114
L_back_115:
    v_mfma_f32_32x32x16_bf16 v[64:79], v[232:235], v[48:51], v[64:79]
    v_mfma_f32_32x32x16_bf16 v[96:111], v[236:239], v[48:51], v[96:111]
    v_mfma_f32_32x32x16_bf16 v[80:95], v[232:235], v[52:55], v[80:95]
    v_mfma_f32_32x32x16_bf16 v[112:127], v[236:239], v[52:55], v[112:127]
    s_nop 7
    s_nop 3
    v_add_u32 v2, s59, v1
    v_add_u32 v3, s57, v1
    s_waitcnt lgkmcnt(0)
    ds_write_b128 v2, v[64:67] offset:0
    ds_write_b128 v2, v[68:71] offset:1024
    ds_write_b128 v2, v[80:83] offset:2048
    ds_write_b128 v2, v[84:87] offset:3072
    ds_write_b128 v2, v[72:75] offset:4096
    ds_write_b128 v2, v[76:79] offset:5120
    ds_write_b128 v2, v[88:91] offset:6144
    ds_write_b128 v2, v[92:95] offset:7168
    ds_write_b128 v3, v[96:99] offset:0
    ds_write_b128 v3, v[100:103] offset:1024
    ds_write_b128 v3, v[112:115] offset:2048
    ds_write_b128 v3, v[116:119] offset:3072
    ds_write_b128 v3, v[104:107] offset:4096
    ds_write_b128 v3, v[108:111] offset:5120
    ds_write_b128 v3, v[120:123] offset:6144
    ds_write_b128 v3, v[124:127] offset:7168
    s_and_b32 s46, s3, 3
    s_lshl_b32 s46, s46, 11
    s_mov_b32 s48, 65536
    s_cmp_lt_u32 s3, 4
    s_cselect_b32 s47, 98304, 0
    s_cselect_b32 s48, 32768, s48
    s_add_u32 s46, s46, s47
    v_add_u32 v2, s46, v1
    v_add_u32 v3, s48, v2
    s_waitcnt lgkmcnt(0)
    s_barrier
    ds_read_b128 v[64:67], v2 offset:0
    ds_read_b128 v[68:71], v2 offset:1024
    ds_read_b128 v[72:75], v2 offset:8192
    ds_read_b128 v[76:79], v2 offset:9216
    ds_read_b128 v[80:83], v2 offset:16384
    ds_read_b128 v[84:87], v2 offset:17408
    ds_read_b128 v[88:91], v2 offset:24576
    ds_read_b128 v[92:95], v2 offset:25600
    ds_read_b128 v[96:99], v3 offset:0
    ds_read_b128 v[100:103], v3 offset:1024
    ds_read_b128 v[104:107], v3 offset:8192
    ds_read_b128 v[108:111], v3 offset:9216
    ds_read_b128 v[112:115], v3 offset:16384
    ds_read_b128 v[116:119], v3 offset:17408
    ds_read_b128 v[120:123], v3 offset:24576
    ds_read_b128 v[124:127], v3 offset:25600
    s_waitcnt lgkmcnt(12)
    v_add_f32 v64, v64, v72
    v_add_f32 v65, v65, v73
    v_add_f32 v66, v66, v74
    v_add_f32 v67, v67, v75
    v_add_f32 v68, v68, v76
    v_add_f32 v69, v69, v77
    v_add_f32 v70, v70, v78
    v_add_f32 v71, v71, v79
    s_waitcnt lgkmcnt(8)
    v_add_f32 v80, v80, v88
    v_add_f32 v81, v81, v89
    v_add_f32 v82, v82, v90
    v_add_f32 v83, v83, v91
    v_add_f32 v84, v84, v92
    v_add_f32 v85, v85, v93
    v_add_f32 v86, v86, v94
    v_add_f32 v87, v87, v95
    s_waitcnt lgkmcnt(4)
    v_add_f32 v96, v96, v104
    v_add_f32 v97, v97, v105
    v_add_f32 v98, v98, v106
    v_add_f32 v99, v99, v107
    v_add_f32 v100, v100, v108
    v_add_f32 v101, v101, v109
    v_add_f32 v102, v102, v110
    v_add_f32 v103, v103, v111
    s_waitcnt lgkmcnt(0)
    v_add_f32 v112, v112, v120
    v_add_f32 v113, v113, v121
    v_add_f32 v114, v114, v122
    v_add_f32 v115, v115, v123
    v_add_f32 v116, v116, v124
    v_add_f32 v117, v117, v125
    v_add_f32 v118, v118, v126
    v_add_f32 v119, v119, v127
    v_add_f32 v64, v64, v80
    v_add_f32 v65, v65, v81
    v_add_f32 v66, v66, v82
    v_add_f32 v67, v67, v83
    v_add_f32 v68, v68, v84
    v_add_f32 v69, v69, v85
    v_add_f32 v70, v70, v86
    v_add_f32 v71, v71, v87
    v_add_f32 v96, v96, v112
    v_add_f32 v97, v97, v113
    v_add_f32 v98, v98, v114
    v_add_f32 v99, v99, v115
    v_add_f32 v100, v100, v116
    v_add_f32 v101, v101, v117
    v_add_f32 v102, v102, v118
    v_add_f32 v103, v103, v119
    v_add_f32 v64, v64, v96
    v_add_f32 v65, v65, v97
    v_add_f32 v66, v66, v98
    v_add_f32 v67, v67, v99
    v_add_f32 v68, v68, v100
    v_add_f32 v69, v69, v101
    v_add_f32 v70, v70, v102
    v_add_f32 v71, v71, v103
    v_lshlrev_b32 v56, 16, v63
    v_lshlrev_b32 v20, 16, v4
    v_and_b32 v21, 0xffff0000, v4
    v_lshlrev_b32 v22, 16, v5
    v_and_b32 v23, 0xffff0000, v5
    v_lshlrev_b32 v24, 16, v6
    v_and_b32 v25, 0xffff0000, v6
    v_lshlrev_b32 v26, 16, v7
    v_and_b32 v27, 0xffff0000, v7
    v_add_f32 v64, v64, v56
    v_add_f32 v65, v65, v56
    v_add_f32 v66, v66, v56
    v_add_f32 v67, v67, v56
    v_add_f32 v68, v68, v56
    v_add_f32 v69, v69, v56
    v_add_f32 v70, v70, v56
    v_add_f32 v71, v71, v56
    v_add_f32 v64, v64, v20
    v_add_f32 v65, v65, v21
    v_add_f32 v66, v66, v22
    v_add_f32 v67, v67, v23
    v_add_f32 v68, v68, v24
    v_add_f32 v69, v69, v25
    v_add_f32 v70, v70, v26
    v_add_f32 v71, v71, v27
    v_cvt_pk_bf16_f32 v28, v64, v65
    v_cvt_pk_bf16_f32 v29, v66, v67
    v_cvt_pk_bf16_f32 v30, v68, v69
    v_cvt_pk_bf16_f32 v31, v70, v71
    s_nop 1
    v_permlane32_swap_b32 v28, v30
    v_permlane32_swap_b32 v29, v31
    v_lshlrev_b32 v57, 10, v57
    v_lshrrev_b32 v2, 5, v0
    v_lshlrev_b32 v2, 4, v2
    v_add_u32 v57, v57, v2
    s_lshl_b32 s46, s26, 7
    s_lshr_b32 s47, s3, 1
    s_lshl_b32 s47, s47, 5
    s_add_u32 s46, s46, s47
    buffer_store_dwordx4 v[28:31], v57, s[40:43], s46 offen
    s_endpgm
L_p2_rare_17:
    s_mov_b32 s55, 1
    s_lshl_b32 s46, s26, 16
    s_add_u32 s47, s46, 2097152
    s_add_u32 s48, s46, 4194304
    v_mov_b32 v2, 0xff800000
    s_mov_b32 s54, 0
L_p2_maxl_15:
    s_add_u32 s49, s47, s54
    buffer_load_dwordx4 v[8:11], v1, s[36:39], s49 offen sc1
    s_waitcnt vmcnt(0)
    v_mfma_f32_32x32x16_bf16 v[32:47], v[8:11], v[4:7], 0
    s_nop 7
    s_nop 3
    v_max3_f32 v2, v2, v32, v33
    v_max3_f32 v2, v2, v34, v35
    v_max3_f32 v2, v2, v36, v37
    v_max3_f32 v2, v2, v38, v39
    v_max3_f32 v2, v2, v40, v41
    v_max3_f32 v2, v2, v42, v43
    v_max3_f32 v2, v2, v44, v45
    v_max3_f32 v2, v2, v46, v47
    s_add_u32 s54, s54, 1024
    s_cmp_lt_u32 s54, 0x10000
    s_cbranch_scc1 L_p2_maxl_15
    v_mov_b32 v3, v2
    s_nop 1
    v_permlane32_swap_b32 v2, v3
    s_nop 1
    v_max_f32 v2, v2, v3
    v_sub_f32 v2, 0, v2
    v_mov_b32 v96, v2
    v_mov_b32 v97, v2
    v_mov_b32 v98, v2
    v_mov_b32 v99, v2
    v_mov_b32 v100, v2
    v_mov_b32 v101, v2
    v_mov_b32 v102, v2
    v_mov_b32 v103, v2
    v_mov_b32 v104, v2
    v_mov_b32 v105, v2
    v_mov_b32 v106, v2
    v_mov_b32 v107, v2
    v_mov_b32 v108, v2
    v_mov_b32 v109, v2
    v_mov_b32 v110, v2
    v_mov_b32 v111, v2
    v_mov_b32 v72, 0
    v_mov_b32 v73, 0
    v_mov_b32 v74, 0
    v_mov_b32 v75, 0
    v_mov_b32 v76, 0
    v_mov_b32 v77, 0
    v_mov_b32 v78, 0
    v_mov_b32 v79, 0
    v_mov_b32 v80, 0
    v_mov_b32 v81, 0
    v_mov_b32 v82, 0
    v_mov_b32 v83, 0
    v_mov_b32 v84, 0
    v_mov_b32 v85, 0
    v_mov_b32 v86, 0
    v_mov_b32 v87, 0
    v_subrev_u32 v89, 0x10000, v91
    s_mov_b32 s54, 0
L_p2_loop_16:
    s_add_u32 s49, s47, s54
    s_add_u32 s50, s48, s54
    buffer_load_dwordx4 v[8:11], v1, s[36:39], s49 offen sc1
    s_mov_b64 exec, s[56:57]
    buffer_load_dwordx4 v[16:19], v89, s[36:39], s50 offen sc1
    buffer_load_dwordx4 v[20:23], v89, s[36:39], s50 offen offset:512 sc1
    s_mov_b64 exec, -1
    s_waitcnt vmcnt(0)
    v_mfma_f32_32x32x16_bf16 v[32:47], v[8:11], v[4:7], v[96:111]
    s_nop 7
    s_nop 3
    v_exp_f32 v32, v32
    v_exp_f32 v33, v33
    v_exp_f32 v34, v34
    v_exp_f32 v35, v35
    v_exp_f32 v36, v36
    v_exp_f32 v37, v37
    v_exp_f32 v38, v38
    v_exp_f32 v39, v39
    v_exp_f32 v40, v40
    v_exp_f32 v41, v41
    v_exp_f32 v42, v42
    v_exp_f32 v43, v43
    v_exp_f32 v44, v44
    v_exp_f32 v45, v45
    v_exp_f32 v46, v46
    v_exp_f32 v47, v47
    s_nop 0
    v_cvt_pk_bf16_f32 v64, v32, v33
    v_cvt_pk_bf16_f32 v65, v34, v35
    v_cvt_pk_bf16_f32 v66, v36, v37
    v_cvt_pk_bf16_f32 v67, v38, v39
    v_cvt_pk_bf16_f32 v68, v40, v41
    v_cvt_pk_bf16_f32 v69, v42, v43
    v_cvt_pk_bf16_f32 v70, v44, v45
    v_cvt_pk_bf16_f32 v71, v46, v47
    s_nop 1
    v_mfma_f32_32x32x16_bf16 v[72:87], v[16:19], v[64:67], v[72:87]
    v_mfma_f32_32x32x16_bf16 v[72:87], v[20:23], v[68:71], v[72:87]
    s_add_u32 s54, s54, 1024
    s_cmp_lt_u32 s54, 0x10000
    s_cbranch_scc1 L_p2_loop_16
    s_nop 7
    s_nop 7
    s_branch L_p2_done_14
L_p4_idle_45:
    s_waitcnt vmcnt(0)
    v_add_u32 v2, s59, v61
    v_add_u32 v3, s59, v62
    ds_read_b64_tr_b16 v[128:129], v2 offset:0
    ds_read_b64_tr_b16 v[130:131], v2 offset:1024
    ds_read_b64_tr_b16 v[132:133], v3 offset:0
    ds_read_b64_tr_b16 v[134:135], v3 offset:1024
    v_add_u32 v2, s59, v61
    v_add_u32 v3, s59, v62
    ds_read_b64_tr_b16 v[136:137], v2 offset:2048
    ds_read_b64_tr_b16 v[138:139], v2 offset:3072
    ds_read_b64_tr_b16 v[140:141], v3 offset:2048
    ds_read_b64_tr_b16 v[142:143], v3 offset:3072
    v_add_u32 v2, s59, v61
    v_add_u32 v3, s59, v62
    ds_read_b64_tr_b16 v[144:145], v2 offset:4096
    ds_read_b64_tr_b16 v[146:147], v2 offset:5120
    ds_read_b64_tr_b16 v[148:149], v3 offset:4096
    ds_read_b64_tr_b16 v[150:151], v3 offset:5120
    s_waitcnt lgkmcnt(0)
    v_add_u32 v2, s59, v61
    v_add_u32 v3, s59, v62
    ds_read_b64_tr_b16 v[152:153], v2 offset:6144
    ds_read_b64_tr_b16 v[154:155], v2 offset:7168
    ds_read_b64_tr_b16 v[156:157], v3 offset:6144
    ds_read_b64_tr_b16 v[158:159], v3 offset:7168
    v_add_u32 v2, s55, v61
    v_add_u32 v3, s55, v62
    ds_read_b64_tr_b16 v[160:161], v2 offset:0
    ds_read_b64_tr_b16 v[162:163], v2 offset:1024
    ds_read_b64_tr_b16 v[164:165], v3 offset:0
    ds_read_b64_tr_b16 v[166:167], v3 offset:1024
    v_add_u32 v2, s57, v61
    v_add_u32 v3, s57, v62
    ds_read_b64_tr_b16 v[168:169], v2 offset:0
    ds_read_b64_tr_b16 v[170:171], v2 offset:1024
    ds_read_b64_tr_b16 v[172:173], v3 offset:0
    ds_read_b64_tr_b16 v[174:175], v3 offset:1024
    s_waitcnt lgkmcnt(0)
    v_add_u32 v2, s57, v61
    v_add_u32 v3, s57, v62
    ds_read_b64_tr_b16 v[176:177], v2 offset:2048
    ds_read_b64_tr_b16 v[178:179], v2 offset:3072
    ds_read_b64_tr_b16 v[180:181], v3 offset:2048
    ds_read_b64_tr_b16 v[182:183], v3 offset:3072
    v_add_u32 v2, s57, v61
    v_add_u32 v3, s57, v62
    ds_read_b64_tr_b16 v[184:185], v2 offset:4096
    ds_read_b64_tr_b16 v[186:187], v2 offset:5120
    ds_read_b64_tr_b16 v[188:189], v3 offset:4096
    ds_read_b64_tr_b16 v[190:191], v3 offset:5120
    v_add_u32 v2, s57, v61
    v_add_u32 v3, s57, v62
    ds_read_b64_tr_b16 v[192:193], v2 offset:6144
    ds_read_b64_tr_b16 v[194:195], v2 offset:7168
    ds_read_b64_tr_b16 v[196:197], v3 offset:6144
    ds_read_b64_tr_b16 v[198:199], v3 offset:7168
    s_waitcnt lgkmcnt(0)
    s_branch L_p4_join_46
L_retry_47:
    s_mov_b32 s53, 0
L_rp_116:
    s_add_u32 s52, s54, 0
    buffer_load_dwordx4 v[8:11], v1, s[36:39], s52 offen sc1
    s_add_u32 s52, s56, 0
    buffer_load_dwordx4 v[12:15], v1, s[36:39], s52 offen sc1
    s_add_u32 s52, s54, 1024
    buffer_load_dwordx4 v[16:19], v1, s[36:39], s52 offen sc1
    s_add_u32 s52, s56, 1024
    buffer_load_dwordx4 v[20:23], v1, s[36:39], s52 offen sc1
    s_add_u32 s52, s54, 2048
    buffer_load_dwordx4 v[24:27], v1, s[36:39], s52 offen sc1
    s_add_u32 s52, s56, 2048
    buffer_load_dwordx4 v[28:31], v1, s[36:39], s52 offen sc1
    s_add_u32 s52, s54, 3072
    buffer_load_dwordx4 v[32:35], v1, s[36:39], s52 offen sc1
    s_add_u32 s52, s56, 3072
    buffer_load_dwordx4 v[36:39], v1, s[36:39], s52 offen sc1
    s_add_u32 s53, s53, 1
    s_waitcnt vmcnt(0)
    s_cmp_ge_u32 s53, 0x100000
    s_cbranch_scc1 L_back_48
    v_cmp_eq_u32 vcc, -1, v8
    v_cmp_eq_u32 s[62:63], -1, v12
    s_or_b64 vcc, vcc, s[62:63]
    s_cbranch_vccnz L_rp_116
    s_branch L_back_48
L_retry_51:
    s_mov_b32 s53, 0
L_rp_117:
    s_add_u32 s52, s54, 1024
    buffer_load_dwordx4 v[16:19], v1, s[36:39], s52 offen sc1
    s_add_u32 s52, s56, 1024
    buffer_load_dwordx4 v[20:23], v1, s[36:39], s52 offen sc1
    s_add_u32 s52, s54, 2048
    buffer_load_dwordx4 v[24:27], v1, s[36:39], s52 offen sc1
    s_add_u32 s52, s56, 2048
    buffer_load_dwordx4 v[28:31], v1, s[36:39], s52 offen sc1
    s_add_u32 s52, s54, 3072
    buffer_load_dwordx4 v[32:35], v1, s[36:39], s52 offen sc1
    s_add_u32 s52, s56, 3072
    buffer_load_dwordx4 v[36:39], v1, s[36:39], s52 offen sc1
    s_add_u32 s52, s54, 4096
    buffer_load_dwordx4 v[40:43], v1, s[36:39], s52 offen sc1
    s_add_u32 s52, s56, 4096
    buffer_load_dwordx4 v[44:47], v1, s[36:39], s52 offen sc1
    s_add_u32 s53, s53, 1
    s_waitcnt vmcnt(0)
    s_cmp_ge_u32 s53, 0x100000
    s_cbranch_scc1 L_back_52
    v_cmp_eq_u32 vcc, -1, v16
    v_cmp_eq_u32 s[62:63], -1, v20
    s_or_b64 vcc, vcc, s[62:63]
    s_cbranch_vccnz L_rp_117
    s_branch L_back_52
L_retry_53:
    s_mov_b32 s53, 0
L_rp_118:
    s_add_u32 s52, s54, 2048
    buffer_load_dwordx4 v[24:27], v1, s[36:39], s52 offen sc1
    s_add_u32 s52, s56, 2048
    buffer_load_dwordx4 v[28:31], v1, s[36:39], s52 offen sc1
    s_add_u32 s52, s54, 3072
    buffer_load_dwordx4 v[32:35], v1, s[36:39], s52 offen sc1
    s_add_u32 s52, s56, 3072
    buffer_load_dwordx4 v[36:39], v1, s[36:39], s52 offen sc1
    s_add_u32 s52, s54, 4096
    buffer_load_dwordx4 v[40:43], v1, s[36:39], s52 offen sc1
    s_add_u32 s52, s56, 4096
    buffer_load_dwordx4 v[44:47], v1, s[36:39], s52 offen sc1
    s_add_u32 s52, s54, 5120
    buffer_load_dwordx4 v[48:51], v1, s[36:39], s52 offen sc1
    s_add_u32 s52, s56, 5120
    buffer_load_dwordx4 v[52:55], v1, s[36:39], s52 offen sc1
    s_add_u32 s53, s53, 1
    s_waitcnt vmcnt(0)
    s_cmp_ge_u32 s53, 0x100000
    s_cbranch_scc1 L_back_54
    v_cmp_eq_u32 vcc, -1, v24
    v_cmp_eq_u32 s[62:63], -1, v28
    s_or_b64 vcc, vcc, s[62:63]
    s_cbranch_vccnz L_rp_118
    s_branch L_back_54
L_retry_55:
    s_mov_b32 s53, 0
L_rp_119:
    s_add_u32 s52, s54, 3072
    buffer_load_dwordx4 v[32:35], v1, s[36:39], s52 offen sc1
    s_add_u32 s52, s56, 3072
    buffer_load_dwordx4 v[36:39], v1, s[36:39], s52 offen sc1
    s_add_u32 s52, s54, 4096
    buffer_load_dwordx4 v[40:43], v1, s[36:39], s52 offen sc1
    s_add_u32 s52, s56, 4096
    buffer_load_dwordx4 v[44:47], v1, s[36:39], s52 offen sc1
    s_add_u32 s52, s54, 5120
    buffer_load_dwordx4 v[48:51], v1, s[36:39], s52 offen sc1
    s_add_u32 s52, s56, 5120
    buffer_load_dwordx4 v[52:55], v1, s[36:39], s52 offen sc1
    s_add_u32 s52, s54, 6144
    buffer_load_dwordx4 v[8:11], v1, s[36:39], s52 offen sc1
    s_add_u32 s52, s56, 6144
    buffer_load_dwordx4 v[12:15], v1, s[36:39], s52 offen sc1
    s_add_u32 s53, s53, 1
    s_waitcnt vmcnt(0)
    s_cmp_ge_u32 s53, 0x100000
    s_cbranch_scc1 L_back_56
    v_cmp_eq_u32 vcc, -1, v32
    v_cmp_eq_u32 s[62:63], -1, v36
    s_or_b64 vcc, vcc, s[62:63]
    s_cbranch_vccnz L_rp_119
    s_branch L_back_56
L_retry_57:
    s_mov_b32 s53, 0
L_rp_120:
    s_add_u32 s52, s54, 4096
    buffer_load_dwordx4 v[40:43], v1, s[36:39], s52 offen sc1
    s_add_u32 s52, s56, 4096
    buffer_load_dwordx4 v[44:47], v1, s[36:39], s52 offen sc1
    s_add_u32 s52, s54, 5120
    buffer_load_dwordx4 v[48:51], v1, s[36:39], s52 offen sc1
    s_add_u32 s52, s56, 5120
    buffer_load_dwordx4 v[52:55], v1, s[36:39], s52 offen sc1
    s_add_u32 s52, s54, 6144
    buffer_load_dwordx4 v[8:11], v1, s[36:39], s52 offen sc1
    s_add_u32 s52, s56, 6144
    buffer_load_dwordx4 v[12:15], v1, s[36:39], s52 offen sc1
    s_add_u32 s52, s54, 7168
    buffer_load_dwordx4 v[128:131], v1, s[36:39], s52 offen sc1
    s_add_u32 s52, s56, 7168
    buffer_load_dwordx4 v[132:135], v1, s[36:39], s52 offen sc1
    s_add_u32 s53, s53, 1
    s_waitcnt vmcnt(0)
    s_cmp_ge_u32 s53, 0x100000
    s_cbranch_scc1 L_back_58
    v_cmp_eq_u32 vcc, -1, v40
    v_cmp_eq_u32 s[62:63], -1, v44
    s_or_b64 vcc, vcc, s[62:63]
    s_cbranch_vccnz L_rp_120
    s_branch L_back_58
L_retry_59:
    s_mov_b32 s53, 0
L_rp_121:
    s_add_u32 s52, s54, 5120
    buffer_load_dwordx4 v[48:51], v1, s[36:39], s52 offen sc1
    s_add_u32 s52, s56, 5120
    buffer_load_dwordx4 v[52:55], v1, s[36:39], s52 offen sc1
    s_add_u32 s52, s54, 6144
    buffer_load_dwordx4 v[8:11], v1, s[36:39], s52 offen sc1
    s_add_u32 s52, s56, 6144
    buffer_load_dwordx4 v[12:15], v1, s[36:39], s52 offen sc1
    s_add_u32 s52, s54, 7168
    buffer_load_dwordx4 v[128:131], v1, s[36:39], s52 offen sc1
    s_add_u32 s52, s56, 7168
    buffer_load_dwordx4 v[132:135], v1, s[36:39], s52 offen sc1
    s_add_u32 s52, s54, 8192
    buffer_load_dwordx4 v[16:19], v1, s[36:39], s52 offen sc1
    s_add_u32 s52, s56, 8192
    buffer_load_dwordx4 v[20:23], v1, s[36:39], s52 offen sc1
    s_add_u32 s53, s53, 1
    s_waitcnt vmcnt(0)
    s_cmp_ge_u32 s53, 0x100000
    s_cbranch_scc1 L_back_60
    v_cmp_eq_u32 vcc, -1, v48
    v_cmp_eq_u32 s[62:63], -1, v52
    s_or_b64 vcc, vcc, s[62:63]
    s_cbranch_vccnz L_rp_121
    s_branch L_back_60
L_retry_61:
    s_mov_b32 s53, 0
L_rp_122:
    s_add_u32 s52, s54, 6144
    buffer_load_dwordx4 v[8:11], v1, s[36:39], s52 offen sc1
    s_add_u32 s52, s56, 6144
    buffer_load_dwordx4 v[12:15], v1, s[36:39], s52 offen sc1
    s_add_u32 s52, s54, 7168
    buffer_load_dwordx4 v[128:131], v1, s[36:39], s52 offen sc1
    s_add_u32 s52, s56, 7168
    buffer_load_dwordx4 v[132:135], v1, s[36:39], s52 offen sc1
    s_add_u32 s52, s54, 8192
    buffer_load_dwordx4 v[16:19], v1, s[36:39], s52 offen sc1
    s_add_u32 s52, s56, 8192
    buffer_load_dwordx4 v[20:23], v1, s[36:39], s52 offen sc1
    s_add_u32 s52, s54, 9216
    buffer_load_dwordx4 v[136:139], v1, s[36:39], s52 offen sc1
    s_add_u32 s52, s56, 9216
    buffer_load_dwordx4 v[140:143], v1, s[36:39], s52 offen sc1
    s_add_u32 s53, s53, 1
    s_waitcnt vmcnt(0)
    s_cmp_ge_u32 s53, 0x100000
    s_cbranch_scc1 L_back_62
    v_cmp_eq_u32 vcc, -1, v8
    v_cmp_eq_u32 s[62:63], -1, v12
    s_or_b64 vcc, vcc, s[62:63]
    s_cbranch_vccnz L_rp_122
    s_branch L_back_62
L_retry_63:
    s_mov_b32 s53, 0
L_rp_123:
    s_add_u32 s52, s54, 7168
    buffer_load_dwordx4 v[128:131], v1, s[36:39], s52 offen sc1
    s_add_u32 s52, s56, 7168
    buffer_load_dwordx4 v[132:135], v1, s[36:39], s52 offen sc1
    s_add_u32 s52, s54, 8192
    buffer_load_dwordx4 v[16:19], v1, s[36:39], s52 offen sc1
    s_add_u32 s52, s56, 8192
    buffer_load_dwordx4 v[20:23], v1, s[36:39], s52 offen sc1
    s_add_u32 s52, s54, 9216
    buffer_load_dwordx4 v[136:139], v1, s[36:39], s52 offen sc1
    s_add_u32 s52, s56, 9216
    buffer_load_dwordx4 v[140:143], v1, s[36:39], s52 offen sc1
    s_add_u32 s52, s54, 10240
    buffer_load_dwordx4 v[24:27], v1, s[36:39], s52 offen sc1
    s_add_u32 s52, s56, 10240
    buffer_load_dwordx4 v[28:31], v1, s[36:39], s52 offen sc1
    s_add_u32 s53, s53, 1
    s_waitcnt vmcnt(0)
    s_cmp_ge_u32 s53, 0x100000
    s_cbranch_scc1 L_back_64
    v_cmp_eq_u32 vcc, -1, v128
    v_cmp_eq_u32 s[62:63], -1, v132
    s_or_b64 vcc, vcc, s[62:63]
    s_cbranch_vccnz L_rp_123
    s_branch L_back_64
L_retry_65:
    s_mov_b32 s53, 0
L_rp_124:
    s_add_u32 s52, s54, 8192
    buffer_load_dwordx4 v[16:19], v1, s[36:39], s52 offen sc1
    s_add_u32 s52, s56, 8192
    buffer_load_dwordx4 v[20:23], v1, s[36:39], s52 offen sc1
    s_add_u32 s52, s54, 9216
    buffer_load_dwordx4 v[136:139], v1, s[36:39], s52 offen sc1
    s_add_u32 s52, s56, 9216
    buffer_load_dwordx4 v[140:143], v1, s[36:39], s52 offen sc1
    s_add_u32 s52, s54, 10240
    buffer_load_dwordx4 v[24:27], v1, s[36:39], s52 offen sc1
    s_add_u32 s52, s56, 10240
    buffer_load_dwordx4 v[28:31], v1, s[36:39], s52 offen sc1
    s_add_u32 s52, s54, 11264
    buffer_load_dwordx4 v[144:147], v1, s[36:39], s52 offen sc1
    s_add_u32 s52, s56, 11264
    buffer_load_dwordx4 v[148:151], v1, s[36:39], s52 offen sc1
    s_add_u32 s53, s53, 1
    s_waitcnt vmcnt(0)
    s_cmp_ge_u32 s53, 0x100000
    s_cbranch_scc1 L_back_66
    v_cmp_eq_u32 vcc, -1, v16
    v_cmp_eq_u32 s[62:63], -1, v20
    s_or_b64 vcc, vcc, s[62:63]
    s_cbranch_vccnz L_rp_124
    s_branch L_back_66
L_retry_67:
    s_mov_b32 s53, 0
L_rp_125:
    s_add_u32 s52, s54, 9216
    buffer_load_dwordx4 v[136:139], v1, s[36:39], s52 offen sc1
    s_add_u32 s52, s56, 9216
    buffer_load_dwordx4 v[140:143], v1, s[36:39], s52 offen sc1
    s_add_u32 s52, s54, 10240
    buffer_load_dwordx4 v[24:27], v1, s[36:39], s52 offen sc1
    s_add_u32 s52, s56, 10240
    buffer_load_dwordx4 v[28:31], v1, s[36:39], s52 offen sc1
    s_add_u32 s52, s54, 11264
    buffer_load_dwordx4 v[144:147], v1, s[36:39], s52 offen sc1
    s_add_u32 s52, s56, 11264
    buffer_load_dwordx4 v[148:151], v1, s[36:39], s52 offen sc1
    s_add_u32 s52, s54, 12288
    buffer_load_dwordx4 v[32:35], v1, s[36:39], s52 offen sc1
    s_add_u32 s52, s56, 12288
    buffer_load_dwordx4 v[36:39], v1, s[36:39], s52 offen sc1
    s_add_u32 s53, s53, 1
    s_waitcnt vmcnt(0)
    s_cmp_ge_u32 s53, 0x100000
    s_cbranch_scc1 L_back_68
    v_cmp_eq_u32 vcc, -1, v136
    v_cmp_eq_u32 s[62:63], -1, v140
    s_or_b64 vcc, vcc, s[62:63]
    s_cbranch_vccnz L_rp_125
    s_branch L_back_68
L_retry_69:
    s_mov_b32 s53, 0
L_rp_126:
    s_add_u32 s52, s54, 10240
    buffer_load_dwordx4 v[24:27], v1, s[36:39], s52 offen sc1
    s_add_u32 s52, s56, 10240
    buffer_load_dwordx4 v[28:31], v1, s[36:39], s52 offen sc1
    s_add_u32 s52, s54, 11264
    buffer_load_dwordx4 v[144:147], v1, s[36:39], s52 offen sc1
    s_add_u32 s52, s56, 11264
    buffer_load_dwordx4 v[148:151], v1, s[36:39], s52 offen sc1
    s_add_u32 s52, s54, 12288
    buffer_load_dwordx4 v[32:35], v1, s[36:39], s52 offen sc1
    s_add_u32 s52, s56, 12288
    buffer_load_dwordx4 v[36:39], v1, s[36:39], s52 offen sc1
    s_add_u32 s52, s54, 13312
    buffer_load_dwordx4 v[152:155], v1, s[36:39], s52 offen sc1
    s_add_u32 s52, s56, 13312
    buffer_load_dwordx4 v[156:159], v1, s[36:39], s52 offen sc1
    s_add_u32 s53, s53, 1
    s_waitcnt vmcnt(0)
    s_cmp_ge_u32 s53, 0x100000
    s_cbranch_scc1 L_back_70
    v_cmp_eq_u32 vcc, -1, v24
    v_cmp_eq_u32 s[62:63], -1, v28
    s_or_b64 vcc, vcc, s[62:63]
    s_cbranch_vccnz L_rp_126
    s_branch L_back_70
L_retry_71:
    s_mov_b32 s53, 0
L_rp_127:
    s_add_u32 s52, s54, 11264
    buffer_load_dwordx4 v[144:147], v1, s[36:39], s52 offen sc1
    s_add_u32 s52, s56, 11264
    buffer_load_dwordx4 v[148:151], v1, s[36:39], s52 offen sc1
    s_add_u32 s52, s54, 12288
    buffer_load_dwordx4 v[32:35], v1, s[36:39], s52 offen sc1
    s_add_u32 s52, s56, 12288
    buffer_load_dwordx4 v[36:39], v1, s[36:39], s52 offen sc1
    s_add_u32 s52, s54, 13312
    buffer_load_dwordx4 v[152:155], v1, s[36:39], s52 offen sc1
    s_add_u32 s52, s56, 13312
    buffer_load_dwordx4 v[156:159], v1, s[36:39], s52 offen sc1
    s_add_u32 s52, s54, 14336
    buffer_load_dwordx4 v[40:43], v1, s[36:39], s52 offen sc1
    s_add_u32 s52, s56, 14336
    buffer_load_dwordx4 v[44:47], v1, s[36:39], s52 offen sc1
    s_add_u32 s53, s53, 1
    s_waitcnt vmcnt(0)
    s_cmp_ge_u32 s53, 0x100000
    s_cbranch_scc1 L_back_72
    v_cmp_eq_u32 vcc, -1, v144
    v_cmp_eq_u32 s[62:63], -1, v148
    s_or_b64 vcc, vcc, s[62:63]
    s_cbranch_vccnz L_rp_127
    s_branch L_back_72
L_retry_73:
    s_mov_b32 s53, 0
L_rp_128:
    s_add_u32 s52, s54, 12288
    buffer_load_dwordx4 v[32:35], v1, s[36:39], s52 offen sc1
    s_add_u32 s52, s56, 12288
    buffer_load_dwordx4 v[36:39], v1, s[36:39], s52 offen sc1
    s_add_u32 s52, s54, 13312
    buffer_load_dwordx4 v[152:155], v1, s[36:39], s52 offen sc1
    s_add_u32 s52, s56, 13312
    buffer_load_dwordx4 v[156:159], v1, s[36:39], s52 offen sc1
    s_add_u32 s52, s54, 14336
    buffer_load_dwordx4 v[40:43], v1, s[36:39], s52 offen sc1
    s_add_u32 s52, s56, 14336
    buffer_load_dwordx4 v[44:47], v1, s[36:39], s52 offen sc1
    s_add_u32 s52, s54, 15360
    buffer_load_dwordx4 v[160:163], v1, s[36:39], s52 offen sc1
    s_add_u32 s52, s56, 15360
    buffer_load_dwordx4 v[164:167], v1, s[36:39], s52 offen sc1
    s_add_u32 s53, s53, 1
    s_waitcnt vmcnt(0)
    s_cmp_ge_u32 s53, 0x100000
    s_cbranch_scc1 L_back_74
    v_cmp_eq_u32 vcc, -1, v32
    v_cmp_eq_u32 s[62:63], -1, v36
    s_or_b64 vcc, vcc, s[62:63]
    s_cbranch_vccnz L_rp_128
    s_branch L_back_74
L_retry_75:
    s_mov_b32 s53, 0
L_rp_129:
    s_add_u32 s52, s54, 13312
    buffer_load_dwordx4 v[152:155], v1, s[36:39], s52 offen sc1
    s_add_u32 s52, s56, 13312
    buffer_load_dwordx4 v[156:159], v1, s[36:39], s52 offen sc1
    s_add_u32 s52, s54, 14336
    buffer_load_dwordx4 v[40:43], v1, s[36:39], s52 offen sc1
    s_add_u32 s52, s56, 14336
    buffer_load_dwordx4 v[44:47], v1, s[36:39], s52 offen sc1
    s_add_u32 s52, s54, 15360
    buffer_load_dwordx4 v[160:163], v1, s[36:39], s52 offen sc1
    s_add_u32 s52, s56, 15360
    buffer_load_dwordx4 v[164:167], v1, s[36:39], s52 offen sc1
    s_add_u32 s53, s53, 1
    s_waitcnt vmcnt(0)
    s_cmp_ge_u32 s53, 0x100000
    s_cbranch_scc1 L_back_76
    v_cmp_eq_u32 vcc, -1, v152
    v_cmp_eq_u32 s[62:63], -1, v156
    s_or_b64 vcc, vcc, s[62:63]
    s_cbranch_vccnz L_rp_129
    s_branch L_back_76
L_retry_77:
    s_mov_b32 s53, 0
L_rp_130:
    s_add_u32 s52, s54, 14336
    buffer_load_dwordx4 v[40:43], v1, s[36:39], s52 offen sc1
    s_add_u32 s52, s56, 14336
    buffer_load_dwordx4 v[44:47], v1, s[36:39], s52 offen sc1
    s_add_u32 s52, s54, 15360
    buffer_load_dwordx4 v[160:163], v1, s[36:39], s52 offen sc1
    s_add_u32 s52, s56, 15360
    buffer_load_dwordx4 v[164:167], v1, s[36:39], s52 offen sc1
    s_add_u32 s53, s53, 1
    s_waitcnt vmcnt(0)
    s_cmp_ge_u32 s53, 0x100000
    s_cbranch_scc1 L_back_78
    v_cmp_eq_u32 vcc, -1, v40
    v_cmp_eq_u32 s[62:63], -1, v44
    s_or_b64 vcc, vcc, s[62:63]
    s_cbranch_vccnz L_rp_130
    s_branch L_back_78
L_retry_79:
    s_mov_b32 s53, 0
L_rp_131:
    s_add_u32 s52, s54, 15360
    buffer_load_dwordx4 v[160:163], v1, s[36:39], s52 offen sc1
    s_add_u32 s52, s56, 15360
    buffer_load_dwordx4 v[164:167], v1, s[36:39], s52 offen sc1
    s_add_u32 s53, s53, 1
    s_waitcnt vmcnt(0)
    s_cmp_ge_u32 s53, 0x100000
    s_cbranch_scc1 L_back_80
    v_cmp_eq_u32 vcc, -1, v160
    v_cmp_eq_u32 s[62:63], -1, v164
    s_or_b64 vcc, vcc, s[62:63]
    s_cbranch_vccnz L_rp_131
    s_branch L_back_80
L_retry_86:
    s_mov_b32 s53, 0
L_rp_132:
    s_add_u32 s52, s54, 0
    buffer_load_dwordx4 v[8:11], v1, s[36:39], s52 offen sc1
    s_add_u32 s52, s56, 0
    buffer_load_dwordx4 v[12:15], v1, s[36:39], s52 offen sc1
    s_add_u32 s52, s54, 1024
    buffer_load_dwordx4 v[16:19], v1, s[36:39], s52 offen sc1
    s_add_u32 s52, s56, 1024
    buffer_load_dwordx4 v[20:23], v1, s[36:39], s52 offen sc1
    s_add_u32 s52, s54, 2048
    buffer_load_dwordx4 v[24:27], v1, s[36:39], s52 offen sc1
    s_add_u32 s52, s56, 2048
    buffer_load_dwordx4 v[28:31], v1, s[36:39], s52 offen sc1
    s_add_u32 s52, s54, 3072
    buffer_load_dwordx4 v[32:35], v1, s[36:39], s52 offen sc1
    s_add_u32 s52, s56, 3072
    buffer_load_dwordx4 v[36:39], v1, s[36:39], s52 offen sc1
    s_add_u32 s53, s53, 1
    s_waitcnt vmcnt(0)
    s_cmp_ge_u32 s53, 0x100000
    s_cbranch_scc1 L_back_87
    v_cmp_eq_u32 vcc, -1, v8
    v_cmp_eq_u32 s[62:63], -1, v12
    s_or_b64 vcc, vcc, s[62:63]
    s_cbranch_vccnz L_rp_132
    s_branch L_back_87
L_retry_90:
    s_mov_b32 s53, 0
L_rp_133:
    s_add_u32 s52, s54, 1024
    buffer_load_dwordx4 v[16:19], v1, s[36:39], s52 offen sc1
    s_add_u32 s52, s56, 1024
    buffer_load_dwordx4 v[20:23], v1, s[36:39], s52 offen sc1
    s_add_u32 s52, s54, 2048
    buffer_load_dwordx4 v[24:27], v1, s[36:39], s52 offen sc1
    s_add_u32 s52, s56, 2048
    buffer_load_dwordx4 v[28:31], v1, s[36:39], s52 offen sc1
    s_add_u32 s52, s54, 3072
    buffer_load_dwordx4 v[32:35], v1, s[36:39], s52 offen sc1
    s_add_u32 s52, s56, 3072
    buffer_load_dwordx4 v[36:39], v1, s[36:39], s52 offen sc1
    s_add_u32 s52, s54, 4096
    buffer_load_dwordx4 v[40:43], v1, s[36:39], s52 offen sc1
    s_add_u32 s52, s56, 4096
    buffer_load_dwordx4 v[44:47], v1, s[36:39], s52 offen sc1
    s_add_u32 s53, s53, 1
    s_waitcnt vmcnt(0)
    s_cmp_ge_u32 s53, 0x100000
    s_cbranch_scc1 L_back_91
    v_cmp_eq_u32 vcc, -1, v16
    v_cmp_eq_u32 s[62:63], -1, v20
    s_or_b64 vcc, vcc, s[62:63]
    s_cbranch_vccnz L_rp_133
    s_branch L_back_91
L_retry_92:
    s_mov_b32 s53, 0
L_rp_134:
    s_add_u32 s52, s54, 2048
    buffer_load_dwordx4 v[24:27], v1, s[36:39], s52 offen sc1
    s_add_u32 s52, s56, 2048
    buffer_load_dwordx4 v[28:31], v1, s[36:39], s52 offen sc1
    s_add_u32 s52, s54, 3072
    buffer_load_dwordx4 v[32:35], v1, s[36:39], s52 offen sc1
    s_add_u32 s52, s56, 3072
    buffer_load_dwordx4 v[36:39], v1, s[36:39], s52 offen sc1
    s_add_u32 s52, s54, 4096
    buffer_load_dwordx4 v[40:43], v1, s[36:39], s52 offen sc1
    s_add_u32 s52, s56, 4096
    buffer_load_dwordx4 v[44:47], v1, s[36:39], s52 offen sc1
    s_add_u32 s52, s54, 5120
    buffer_load_dwordx4 v[48:51], v1, s[36:39], s52 offen sc1
    s_add_u32 s52, s56, 5120
    buffer_load_dwordx4 v[52:55], v1, s[36:39], s52 offen sc1
    s_add_u32 s53, s53, 1
    s_waitcnt vmcnt(0)
    s_cmp_ge_u32 s53, 0x100000
    s_cbranch_scc1 L_back_93
    v_cmp_eq_u32 vcc, -1, v24
    v_cmp_eq_u32 s[62:63], -1, v28
    s_or_b64 vcc, vcc, s[62:63]
    s_cbranch_vccnz L_rp_134
    s_branch L_back_93
L_retry_94:
    s_mov_b32 s53, 0
L_rp_135:
    s_add_u32 s52, s54, 3072
    buffer_load_dwordx4 v[32:35], v1, s[36:39], s52 offen sc1
    s_add_u32 s52, s56, 3072
    buffer_load_dwordx4 v[36:39], v1, s[36:39], s52 offen sc1
    s_add_u32 s52, s54, 4096
    buffer_load_dwordx4 v[40:43], v1, s[36:39], s52 offen sc1
    s_add_u32 s52, s56, 4096
    buffer_load_dwordx4 v[44:47], v1, s[36:39], s52 offen sc1
    s_add_u32 s52, s54, 5120
    buffer_load_dwordx4 v[48:51], v1, s[36:39], s52 offen sc1
    s_add_u32 s52, s56, 5120
    buffer_load_dwordx4 v[52:55], v1, s[36:39], s52 offen sc1
    s_add_u32 s52, s54, 6144
    buffer_load_dwordx4 v[8:11], v1, s[36:39], s52 offen sc1
    s_add_u32 s52, s56, 6144
    buffer_load_dwordx4 v[12:15], v1, s[36:39], s52 offen sc1
    s_add_u32 s53, s53, 1
    s_waitcnt vmcnt(0)
    s_cmp_ge_u32 s53, 0x100000
    s_cbranch_scc1 L_back_95
    v_cmp_eq_u32 vcc, -1, v32
    v_cmp_eq_u32 s[62:63], -1, v36
    s_or_b64 vcc, vcc, s[62:63]
    s_cbranch_vccnz L_rp_135
    s_branch L_back_95
L_retry_96:
    s_mov_b32 s53, 0
L_rp_136:
    s_add_u32 s52, s54, 4096
    buffer_load_dwordx4 v[40:43], v1, s[36:39], s52 offen sc1
    s_add_u32 s52, s56, 4096
    buffer_load_dwordx4 v[44:47], v1, s[36:39], s52 offen sc1
    s_add_u32 s52, s54, 5120
    buffer_load_dwordx4 v[48:51], v1, s[36:39], s52 offen sc1
    s_add_u32 s52, s56, 5120
    buffer_load_dwordx4 v[52:55], v1, s[36:39], s52 offen sc1
    s_add_u32 s52, s54, 6144
    buffer_load_dwordx4 v[8:11], v1, s[36:39], s52 offen sc1
    s_add_u32 s52, s56, 6144
    buffer_load_dwordx4 v[12:15], v1, s[36:39], s52 offen sc1
    s_add_u32 s52, s54, 7168
    buffer_load_dwordx4 v[200:203], v1, s[36:39], s52 offen sc1
    s_add_u32 s52, s56, 7168
    buffer_load_dwordx4 v[204:207], v1, s[36:39], s52 offen sc1
    s_add_u32 s53, s53, 1
    s_waitcnt vmcnt(0)
    s_cmp_ge_u32 s53, 0x100000
    s_cbranch_scc1 L_back_97
    v_cmp_eq_u32 vcc, -1, v40
    v_cmp_eq_u32 s[62:63], -1, v44
    s_or_b64 vcc, vcc, s[62:63]
    s_cbranch_vccnz L_rp_136
    s_branch L_back_97
L_retry_98:
    s_mov_b32 s53, 0
L_rp_137:
    s_add_u32 s52, s54, 5120
    buffer_load_dwordx4 v[48:51], v1, s[36:39], s52 offen sc1
    s_add_u32 s52, s56, 5120
    buffer_load_dwordx4 v[52:55], v1, s[36:39], s52 offen sc1
    s_add_u32 s52, s54, 6144
    buffer_load_dwordx4 v[8:11], v1, s[36:39], s52 offen sc1
    s_add_u32 s52, s56, 6144
    buffer_load_dwordx4 v[12:15], v1, s[36:39], s52 offen sc1
    s_add_u32 s52, s54, 7168
    buffer_load_dwordx4 v[200:203], v1, s[36:39], s52 offen sc1
    s_add_u32 s52, s56, 7168
    buffer_load_dwordx4 v[204:207], v1, s[36:39], s52 offen sc1
    s_add_u32 s52, s54, 8192
    buffer_load_dwordx4 v[208:211], v1, s[36:39], s52 offen sc1
    s_add_u32 s52, s56, 8192
    buffer_load_dwordx4 v[212:215], v1, s[36:39], s52 offen sc1
    s_add_u32 s53, s53, 1
    s_waitcnt vmcnt(0)
    s_cmp_ge_u32 s53, 0x100000
    s_cbranch_scc1 L_back_99
    v_cmp_eq_u32 vcc, -1, v48
    v_cmp_eq_u32 s[62:63], -1, v52
    s_or_b64 vcc, vcc, s[62:63]
    s_cbranch_vccnz L_rp_137
    s_branch L_back_99
L_retry_100:
    s_mov_b32 s53, 0
L_rp_138:
    s_add_u32 s52, s54, 6144
    buffer_load_dwordx4 v[8:11], v1, s[36:39], s52 offen sc1
    s_add_u32 s52, s56, 6144
    buffer_load_dwordx4 v[12:15], v1, s[36:39], s52 offen sc1
    s_add_u32 s52, s54, 7168
    buffer_load_dwordx4 v[200:203], v1, s[36:39], s52 offen sc1
    s_add_u32 s52, s56, 7168
    buffer_load_dwordx4 v[204:207], v1, s[36:39], s52 offen sc1
    s_add_u32 s52, s54, 8192
    buffer_load_dwordx4 v[208:211], v1, s[36:39], s52 offen sc1
    s_add_u32 s52, s56, 8192
    buffer_load_dwordx4 v[212:215], v1, s[36:39], s52 offen sc1
    s_add_u32 s52, s54, 9216
    buffer_load_dwordx4 v[16:19], v1, s[36:39], s52 offen sc1
    s_add_u32 s52, s56, 9216
    buffer_load_dwordx4 v[20:23], v1, s[36:39], s52 offen sc1
    s_add_u32 s53, s53, 1
    s_waitcnt vmcnt(0)
    s_cmp_ge_u32 s53, 0x100000
    s_cbranch_scc1 L_back_101
    v_cmp_eq_u32 vcc, -1, v8
    v_cmp_eq_u32 s[62:63], -1, v12
    s_or_b64 vcc, vcc, s[62:63]
    s_cbranch_vccnz L_rp_138
    s_branch L_back_101
L_retry_102:
    s_mov_b32 s53, 0
L_rp_139:
    s_add_u32 s52, s54, 7168
    buffer_load_dwordx4 v[200:203], v1, s[36:39], s52 offen sc1
    s_add_u32 s52, s56, 7168
    buffer_load_dwordx4 v[204:207], v1, s[36:39], s52 offen sc1
    s_add_u32 s52, s54, 8192
    buffer_load_dwordx4 v[208:211], v1, s[36:39], s52 offen sc1
    s_add_u32 s52, s56, 8192
    buffer_load_dwordx4 v[212:215], v1, s[36:39], s52 offen sc1
    s_add_u32 s52, s54, 9216
    buffer_load_dwordx4 v[16:19], v1, s[36:39], s52 offen sc1
    s_add_u32 s52, s56, 9216
    buffer_load_dwordx4 v[20:23], v1, s[36:39], s52 offen sc1
    s_add_u32 s52, s54, 10240
    buffer_load_dwordx4 v[216:219], v1, s[36:39], s52 offen sc1
    s_add_u32 s52, s56, 10240
    buffer_load_dwordx4 v[220:223], v1, s[36:39], s52 offen sc1
    s_add_u32 s53, s53, 1
    s_waitcnt vmcnt(0)
    s_cmp_ge_u32 s53, 0x100000
    s_cbranch_scc1 L_back_103
    v_cmp_eq_u32 vcc, -1, v200
    v_cmp_eq_u32 s[62:63], -1, v204
    s_or_b64 vcc, vcc, s[62:63]
    s_cbranch_vccnz L_rp_139
    s_branch L_back_103
L_retry_104:
    s_mov_b32 s53, 0
L_rp_140:
    s_add_u32 s52, s54, 8192
    buffer_load_dwordx4 v[208:211], v1, s[36:39], s52 offen sc1
    s_add_u32 s52, s56, 8192
    buffer_load_dwordx4 v[212:215], v1, s[36:39], s52 offen sc1
    s_add_u32 s52, s54, 9216
    buffer_load_dwordx4 v[16:19], v1, s[36:39], s52 offen sc1
    s_add_u32 s52, s56, 9216
    buffer_load_dwordx4 v[20:23], v1, s[36:39], s52 offen sc1
    s_add_u32 s52, s54, 10240
    buffer_load_dwordx4 v[216:219], v1, s[36:39], s52 offen sc1
    s_add_u32 s52, s56, 10240
    buffer_load_dwordx4 v[220:223], v1, s[36:39], s52 offen sc1
    s_add_u32 s52, s54, 11264
    buffer_load_dwordx4 v[224:227], v1, s[36:39], s52 offen sc1
    s_add_u32 s52, s56, 11264
    buffer_load_dwordx4 v[228:231], v1, s[36:39], s52 offen sc1
    s_add_u32 s53, s53, 1
    s_waitcnt vmcnt(0)
    s_cmp_ge_u32 s53, 0x100000
    s_cbranch_scc1 L_back_105
    v_cmp_eq_u32 vcc, -1, v208
    v_cmp_eq_u32 s[62:63], -1, v212
    s_or_b64 vcc, vcc, s[62:63]
    s_cbranch_vccnz L_rp_140
    s_branch L_back_105
L_retry_106:
    s_mov_b32 s53, 0
L_rp_141:
    s_add_u32 s52, s54, 9216
    buffer_load_dwordx4 v[16:19], v1, s[36:39], s52 offen sc1
    s_add_u32 s52, s56, 9216
    buffer_load_dwordx4 v[20:23], v1, s[36:39], s52 offen sc1
    s_add_u32 s52, s54, 10240
    buffer_load_dwordx4 v[216:219], v1, s[36:39], s52 offen sc1
    s_add_u32 s52, s56, 10240
    buffer_load_dwordx4 v[220:223], v1, s[36:39], s52 offen sc1
    s_add_u32 s52, s54, 11264
    buffer_load_dwordx4 v[224:227], v1, s[36:39], s52 offen sc1
    s_add_u32 s52, s56, 11264
    buffer_load_dwordx4 v[228:231], v1, s[36:39], s52 offen sc1
    s_add_u32 s52, s54, 12288
    buffer_load_dwordx4 v[24:27], v1, s[36:39], s52 offen sc1
    s_add_u32 s52, s56, 12288
    buffer_load_dwordx4 v[28:31], v1, s[36:39], s52 offen sc1
    s_add_u32 s53, s53, 1
    s_waitcnt vmcnt(0)
    s_cmp_ge_u32 s53, 0x100000
    s_cbranch_scc1 L_back_107
    v_cmp_eq_u32 vcc, -1, v16
    v_cmp_eq_u32 s[62:63], -1, v20
    s_or_b64 vcc, vcc, s[62:63]
    s_cbranch_vccnz L_rp_141
    s_branch L_back_107
L_retry_108:
    s_mov_b32 s53, 0
L_rp_142:
    s_add_u32 s52, s54, 10240
    buffer_load_dwordx4 v[216:219], v1, s[36:39], s52 offen sc1
    s_add_u32 s52, s56, 10240
    buffer_load_dwordx4 v[220:223], v1, s[36:39], s52 offen sc1
    s_add_u32 s52, s54, 11264
    buffer_load_dwordx4 v[224:227], v1, s[36:39], s52 offen sc1
    s_add_u32 s52, s56, 11264
    buffer_load_dwordx4 v[228:231], v1, s[36:39], s52 offen sc1
    s_add_u32 s52, s54, 12288
    buffer_load_dwordx4 v[24:27], v1, s[36:39], s52 offen sc1
    s_add_u32 s52, s56, 12288
    buffer_load_dwordx4 v[28:31], v1, s[36:39], s52 offen sc1
    s_add_u32 s52, s54, 13312
    buffer_load_dwordx4 v[232:235], v1, s[36:39], s52 offen sc1
    s_add_u32 s52, s56, 13312
    buffer_load_dwordx4 v[236:239], v1, s[36:39], s52 offen sc1
    s_add_u32 s53, s53, 1
    s_waitcnt vmcnt(0)
    s_cmp_ge_u32 s53, 0x100000
    s_cbranch_scc1 L_back_109
    v_cmp_eq_u32 vcc, -1, v216
    v_cmp_eq_u32 s[62:63], -1, v220
    s_or_b64 vcc, vcc, s[62:63]
    s_cbranch_vccnz L_rp_142
    s_branch L_back_109
L_retry_110:
    s_mov_b32 s53, 0
L_rp_143:
    s_add_u32 s52, s54, 11264
    buffer_load_dwordx4 v[224:227], v1, s[36:39], s52 offen sc1
    s_add_u32 s52, s56, 11264
    buffer_load_dwordx4 v[228:231], v1, s[36:39], s52 offen sc1
    s_add_u32 s52, s54, 12288
    buffer_load_dwordx4 v[24:27], v1, s[36:39], s52 offen sc1
    s_add_u32 s52, s56, 12288
    buffer_load_dwordx4 v[28:31], v1, s[36:39], s52 offen sc1
    s_add_u32 s52, s54, 13312
    buffer_load_dwordx4 v[232:235], v1, s[36:39], s52 offen sc1
    s_add_u32 s52, s56, 13312
    buffer_load_dwordx4 v[236:239], v1, s[36:39], s52 offen sc1
    s_add_u32 s53, s53, 1
    s_waitcnt vmcnt(0)
    s_cmp_ge_u32 s53, 0x100000
    s_cbranch_scc1 L_back_111
    v_cmp_eq_u32 vcc, -1, v224
    v_cmp_eq_u32 s[62:63], -1, v228
    s_or_b64 vcc, vcc, s[62:63]
    s_cbranch_vccnz L_rp_143
    s_branch L_back_111
L_retry_112:
    s_mov_b32 s53, 0
L_rp_144:
    s_add_u32 s52, s54, 12288
    buffer_load_dwordx4 v[24:27], v1, s[36:39], s52 offen sc1
    s_add_u32 s52, s56, 12288
    buffer_load_dwordx4 v[28:31], v1, s[36:39], s52 offen sc1
    s_add_u32 s52, s54, 13312
    buffer_load_dwordx4 v[232:235], v1, s[36:39], s52 offen sc1
    s_add_u32 s52, s56, 13312
    buffer_load_dwordx4 v[236:239], v1, s[36:39], s52 offen sc1
    s_add_u32 s53, s53, 1
    s_waitcnt vmcnt(0)
    s_cmp_ge_u32 s53, 0x100000
    s_cbranch_scc1 L_back_113
    v_cmp_eq_u32 vcc, -1, v24
    v_cmp_eq_u32 s[62:63], -1, v28
    s_or_b64 vcc, vcc, s[62:63]
    s_cbranch_vccnz L_rp_144
    s_branch L_back_113
L_retry_114:
    s_mov_b32 s53, 0
L_rp_145:
    s_add_u32 s52, s54, 13312
    buffer_load_dwordx4 v[232:235], v1, s[36:39], s52 offen sc1
    s_add_u32 s52, s56, 13312
    buffer_load_dwordx4 v[236:239], v1, s[36:39], s52 offen sc1
    s_add_u32 s53, s53, 1
    s_waitcnt vmcnt(0)
    s_cmp_ge_u32 s53, 0x100000
    s_cbranch_scc1 L_back_115
    v_cmp_eq_u32 vcc, -1, v232
    v_cmp_eq_u32 s[62:63], -1, v236
    s_or_b64 vcc, vcc, s[62:63]
    s_cbranch_vccnz L_rp_145
    s_branch L_back_115
L_os_r_23:
    s_mov_b32 s48, 0
L_os_p_146:
    buffer_load_dwordx4 v[8:11], v1, s[36:39], s50 offen offset:0 sc1
L_os_k_147:
    v_cmp_eq_u32 vcc, -1, v12
    s_cbranch_vccz L_os_k_148
    buffer_load_dwordx4 v[12:15], v1, s[36:39], s50 offen offset:1024 sc1
L_os_k_148:
    v_cmp_eq_u32 vcc, -1, v16
    s_cbranch_vccz L_os_k_149
    buffer_load_dwordx4 v[16:19], v1, s[36:39], s50 offen offset:2048 sc1
L_os_k_149:
    v_cmp_eq_u32 vcc, -1, v20
    s_cbranch_vccz L_os_k_150
    buffer_load_dwordx4 v[20:23], v1, s[36:39], s50 offen offset:3072 sc1
L_os_k_150:
    v_cmp_eq_u32 vcc, -1, v24
    s_cbranch_vccz L_os_k_151
    buffer_load_dwordx4 v[24:27], v1, s[36:39], s51 offen offset:0 sc1
L_os_k_151:
    v_cmp_eq_u32 vcc, -1, v28
    s_cbranch_vccz L_os_k_152
    buffer_load_dwordx4 v[28:31], v1, s[36:39], s51 offen offset:1024 sc1
L_os_k_152:
    v_cmp_eq_u32 vcc, -1, v32
    s_cbranch_vccz L_os_k_153
    buffer_load_dwordx4 v[32:35], v1, s[36:39], s51 offen offset:2048 sc1
L_os_k_153:
    v_cmp_eq_u32 vcc, -1, v36
    s_cbranch_vccz L_os_k_154
    buffer_load_dwordx4 v[36:39], v1, s[36:39], s51 offen offset:3072 sc1
L_os_k_154:
    s_add_u32 s48, s48, 1
    s_waitcnt vmcnt(0)
    s_cmp_ge_u32 s48, 0x100000
    s_cbranch_scc1 L_os_b_24
    v_cmp_eq_u32 vcc, -1, v8
    s_cbranch_vccnz L_os_p_146
    s_branch L_os_b_24
L_os_r_25:
    s_mov_b32 s48, 0
L_os_p_155:
    buffer_load_dwordx4 v[12:15], v1, s[36:39], s50 offen offset:1024 sc1
L_os_k_156:
    v_cmp_eq_u32 vcc, -1, v16
    s_cbranch_vccz L_os_k_157
    buffer_load_dwordx4 v[16:19], v1, s[36:39], s50 offen offset:2048 sc1
L_os_k_157:
    v_cmp_eq_u32 vcc, -1, v20
    s_cbranch_vccz L_os_k_158
    buffer_load_dwordx4 v[20:23], v1, s[36:39], s50 offen offset:3072 sc1
L_os_k_158:
    v_cmp_eq_u32 vcc, -1, v24
    s_cbranch_vccz L_os_k_159
    buffer_load_dwordx4 v[24:27], v1, s[36:39], s51 offen offset:0 sc1
L_os_k_159:
    v_cmp_eq_u32 vcc, -1, v28
    s_cbranch_vccz L_os_k_160
    buffer_load_dwordx4 v[28:31], v1, s[36:39], s51 offen offset:1024 sc1
L_os_k_160:
    v_cmp_eq_u32 vcc, -1, v32
    s_cbranch_vccz L_os_k_161
    buffer_load_dwordx4 v[32:35], v1, s[36:39], s51 offen offset:2048 sc1
L_os_k_161:
    v_cmp_eq_u32 vcc, -1, v36
    s_cbranch_vccz L_os_k_162
    buffer_load_dwordx4 v[36:39], v1, s[36:39], s51 offen offset:3072 sc1
L_os_k_162:
    s_add_u32 s48, s48, 1
    s_waitcnt vmcnt(0)
    s_cmp_ge_u32 s48, 0x100000
    s_cbranch_scc1 L_os_b_26
    v_cmp_eq_u32 vcc, -1, v12
    s_cbranch_vccnz L_os_p_155
    s_branch L_os_b_26
L_os_r_27:
    s_mov_b32 s48, 0
L_os_p_163:
    buffer_load_dwordx4 v[16:19], v1, s[36:39], s50 offen offset:2048 sc1
L_os_k_164:
    v_cmp_eq_u32 vcc, -1, v20
    s_cbranch_vccz L_os_k_165
    buffer_load_dwordx4 v[20:23], v1, s[36:39], s50 offen offset:3072 sc1
L_os_k_165:
    v_cmp_eq_u32 vcc, -1, v24
    s_cbranch_vccz L_os_k_166
    buffer_load_dwordx4 v[24:27], v1, s[36:39], s51 offen offset:0 sc1
L_os_k_166:
    v_cmp_eq_u32 vcc, -1, v28
    s_cbranch_vccz L_os_k_167
    buffer_load_dwordx4 v[28:31], v1, s[36:39], s51 offen offset:1024 sc1
L_os_k_167:
    v_cmp_eq_u32 vcc, -1, v32
    s_cbranch_vccz L_os_k_168
    buffer_load_dwordx4 v[32:35], v1, s[36:39], s51 offen offset:2048 sc1
L_os_k_168:
    v_cmp_eq_u32 vcc, -1, v36
    s_cbranch_vccz L_os_k_169
    buffer_load_dwordx4 v[36:39], v1, s[36:39], s51 offen offset:3072 sc1
L_os_k_169:
    s_add_u32 s48, s48, 1
    s_waitcnt vmcnt(0)
    s_cmp_ge_u32 s48, 0x100000
    s_cbranch_scc1 L_os_b_28
    v_cmp_eq_u32 vcc, -1, v16
    s_cbranch_vccnz L_os_p_163
    s_branch L_os_b_28
L_os_r_29:
    s_mov_b32 s48, 0
L_os_p_170:
    buffer_load_dwordx4 v[20:23], v1, s[36:39], s50 offen offset:3072 sc1
L_os_k_171:
    v_cmp_eq_u32 vcc, -1, v24
    s_cbranch_vccz L_os_k_172
    buffer_load_dwordx4 v[24:27], v1, s[36:39], s51 offen offset:0 sc1
L_os_k_172:
    v_cmp_eq_u32 vcc, -1, v28
    s_cbranch_vccz L_os_k_173
    buffer_load_dwordx4 v[28:31], v1, s[36:39], s51 offen offset:1024 sc1
L_os_k_173:
    v_cmp_eq_u32 vcc, -1, v32
    s_cbranch_vccz L_os_k_174
    buffer_load_dwordx4 v[32:35], v1, s[36:39], s51 offen offset:2048 sc1
L_os_k_174:
    v_cmp_eq_u32 vcc, -1, v36
    s_cbranch_vccz L_os_k_175
    buffer_load_dwordx4 v[36:39], v1, s[36:39], s51 offen offset:3072 sc1
L_os_k_175:
    s_add_u32 s48, s48, 1
    s_waitcnt vmcnt(0)
    s_cmp_ge_u32 s48, 0x100000
    s_cbranch_scc1 L_os_b_30
    v_cmp_eq_u32 vcc, -1, v20
    s_cbranch_vccnz L_os_p_170
    s_branch L_os_b_30
L_os_r_31:
    s_mov_b32 s48, 0
L_os_p_176:
    buffer_load_dwordx4 v[24:27], v1, s[36:39], s51 offen offset:0 sc1
L_os_k_177:
    v_cmp_eq_u32 vcc, -1, v28
    s_cbranch_vccz L_os_k_178
    buffer_load_dwordx4 v[28:31], v1, s[36:39], s51 offen offset:1024 sc1
L_os_k_178:
    v_cmp_eq_u32 vcc, -1, v32
    s_cbranch_vccz L_os_k_179
    buffer_load_dwordx4 v[32:35], v1, s[36:39], s51 offen offset:2048 sc1
L_os_k_179:
    v_cmp_eq_u32 vcc, -1, v36
    s_cbranch_vccz L_os_k_180
    buffer_load_dwordx4 v[36:39], v1, s[36:39], s51 offen offset:3072 sc1
L_os_k_180:
    s_add_u32 s48, s48, 1
    s_waitcnt vmcnt(0)
    s_cmp_ge_u32 s48, 0x100000
    s_cbranch_scc1 L_os_b_32
    v_cmp_eq_u32 vcc, -1, v24
    s_cbranch_vccnz L_os_p_176
    s_branch L_os_b_32
L_os_r_33:
    s_mov_b32 s48, 0
L_os_p_181:
    buffer_load_dwordx4 v[28:31], v1, s[36:39], s51 offen offset:1024 sc1
L_os_k_182:
    v_cmp_eq_u32 vcc, -1, v32
    s_cbranch_vccz L_os_k_183
    buffer_load_dwordx4 v[32:35], v1, s[36:39], s51 offen offset:2048 sc1
L_os_k_183:
    v_cmp_eq_u32 vcc, -1, v36
    s_cbranch_vccz L_os_k_184
    buffer_load_dwordx4 v[36:39], v1, s[36:39], s51 offen offset:3072 sc1
L_os_k_184:
    s_add_u32 s48, s48, 1
    s_waitcnt vmcnt(0)
    s_cmp_ge_u32 s48, 0x100000
    s_cbranch_scc1 L_os_b_34
    v_cmp_eq_u32 vcc, -1, v28
    s_cbranch_vccnz L_os_p_181
    s_branch L_os_b_34
L_os_r_35:
    s_mov_b32 s48, 0
L_os_p_185:
    buffer_load_dwordx4 v[32:35], v1, s[36:39], s51 offen offset:2048 sc1
L_os_k_186:
    v_cmp_eq_u32 vcc, -1, v36
    s_cbranch_vccz L_os_k_187
    buffer_load_dwordx4 v[36:39], v1, s[36:39], s51 offen offset:3072 sc1
L_os_k_187:
    s_add_u32 s48, s48, 1
    s_waitcnt vmcnt(0)
    s_cmp_ge_u32 s48, 0x100000
    s_cbranch_scc1 L_os_b_36
    v_cmp_eq_u32 vcc, -1, v32
    s_cbranch_vccnz L_os_p_185
    s_branch L_os_b_36
L_os_r_37:
    s_mov_b32 s48, 0
L_os_p_188:
    buffer_load_dwordx4 v[36:39], v1, s[36:39], s51 offen offset:3072 sc1
L_os_k_189:
    s_add_u32 s48, s48, 1
    s_waitcnt vmcnt(0)
    s_cmp_ge_u32 s48, 0x100000
    s_cbranch_scc1 L_os_b_38
    v_cmp_eq_u32 vcc, -1, v36
    s_cbranch_vccnz L_os_p_188
    s_branch L_os_b_38
L_end:
L_codeend:
    s_endpgm
.section .rodata,"a"
.p2align 6
.amdhsa_kernel sequential_preLN__mha_block__mixer_token_mlp__prompt_kernel
  .amdhsa_next_free_vgpr 256
  .amdhsa_next_free_sgpr 102
  .amdhsa_accum_offset 256
  .amdhsa_group_segment_fixed_size 0
  .amdhsa_kernarg_size 88
  .amdhsa_user_sgpr_count 2
  .amdhsa_user_sgpr_kernarg_segment_ptr 1
  .amdhsa_system_sgpr_workgroup_id_x 1
  .amdhsa_float_denorm_mode_32 3
.end_amdhsa_kernel
```
